```python
import torch

def _softmax(x, axis=-1):
    return torch.softmax(x, dim=axis)
def _gelu(x):
    return torch.nn.functional.gelu(x, approximate="tanh")
def _silu(x):
    return torch.nn.functional.silu(x)
def _sigmoid(x):
    return torch.sigmoid(x)
def _layernorm(x, axis=-1, eps=1e-5):
    m = x.mean(dim=axis, keepdim=True)
    v = x.var(dim=axis, keepdim=True, unbiased=False)
    return (x - m) / torch.sqrt(v + eps)
def _scatter_add(tgt, idx, src, axis=0):
    return tgt.clone().index_add_(axis, idx, src)
def _segment_sum(src, seg, n):
    out = torch.zeros((n,) + src.shape[1:], dtype=src.dtype)
    return out.index_add_(0, seg, src)
def _pad(x, pw):
    flat = tuple(v for pair in reversed(pw) for v in pair)
    return torch.nn.functional.pad(x, flat)

kernel_name = 'sequential_preLN__sliding_block_cached__dense_activation_silu__decode'

def setup_inputs():

    _w = (lambda a: (lambda t: t.to(torch.bfloat16) if t.is_floating_point() else t)(torch.as_tensor(a)))
    def _A_setup():
        B, Sq, D = 8, 1, 640
        Hq, Hkv, Sk, Dh = 32, 32, 4096, 192
        assert Hq % Hkv == 0, (Hq, Hkv)
        return {
            "x": _w((lambda *s: torch.randn(*s, dtype=torch.bfloat16) * 0.05)(B, Sq, D)),
            "k_cache": _w((lambda *s: torch.randn(*s, dtype=torch.bfloat16) * 3.2)(B, Hkv, Sk, Dh)),
            "v_cache": _w((lambda *s: torch.randn(*s, dtype=torch.bfloat16) * 0.8)(B, Hkv, Sk, Dh)),
            "wq": _w((lambda *s: torch.randn(*s, dtype=torch.bfloat16) * 3.2)(D, Hq * Dh) * (D ** -0.5)),
            "wo": _w((lambda *s: torch.randn(*s, dtype=torch.bfloat16) * 0.8)(Hq * Dh, D) * ((Hq * Dh) ** -0.5)),
        }
    _A_in = _A_setup()

    def _B_setup():
        B, S, D, F = 8, 1, 640, 1536
        return {
            "x": _w((lambda *s: torch.randn(*s, dtype=torch.bfloat16) * 0.05)(B, S, D)),
            "w1": _w((lambda *s: torch.randn(*s, dtype=torch.bfloat16) * 3.2)(D, F) * (D ** -0.5)),
            "w2": _w((lambda *s: torch.randn(*s, dtype=torch.bfloat16) * 0.4)(F, D) * (F ** -0.5)),
        }
    _B_in = _B_setup()

    return {
        "A_x": _A_in["x"],
        "A_k_cache": _A_in["k_cache"],
        "A_v_cache": _A_in["v_cache"],
        "A_wq": _A_in["wq"],
        "A_wo": _A_in["wo"],
        "B_x": _B_in["x"],
        "B_w1": _B_in["w1"],
        "B_w2": _B_in["w2"],
    }

def reference(A_x, A_k_cache, A_v_cache, A_wq, A_wo, B_x, B_w1, B_w2):
    def _A_ref(x, k_cache, v_cache, wq, wo):
        B, Sq, D = x.shape
        Hq, Dh = 32, 192
        Hkv, Sk = k_cache.shape[1], k_cache.shape[2]
        W = min(4096, max(256, Sk // 4))
        rep = Hq // Hkv
        q = (lambda x, *d: x.permute(*d))((x @ wq).reshape(B, Sq, Hq, Dh), 0, 2, 1, 3)
        k = (lambda x, n, axis: torch.repeat_interleave(x, n, dim=axis))(k_cache[:, :, Sk - W:, :], rep, axis=1)
        v = (lambda x, n, axis: torch.repeat_interleave(x, n, dim=axis))(v_cache[:, :, Sk - W:, :], rep, axis=1)
        scores = torch.einsum("bhqd,bhkd->bhqk", q, k) * (Dh ** -0.5)
        p = _softmax(scores, axis=-1)
        o = torch.einsum("bhqk,bhkd->bhqd", p, v)
        return (lambda x, *d: x.permute(*d))(o, 0, 2, 1, 3).reshape(B, Sq, Hq * Dh) @ wo

    def _B_ref(x, w1, w2):
        h = torch.einsum("bsd,df->bsf", x, w1)
        h = _silu(h)
        out = torch.einsum("bsf,fd->bsd", h, w2)
        return out

    x = A_x
    h = x + _A_ref(_layernorm(x, axis=-1), A_k_cache, A_v_cache, A_wq, A_wo)
    h2 = h + _B_ref(_layernorm(h, axis=-1), B_w1, B_w2)
    return h2
```

```asm
; @launch grid=(256,1,1) block=(256,1,1) lds=152576
.amdgcn_target "amdgcn-amd-amdhsa--gfx950"
.text
.globl sequential_preLN__sliding_block_cached__dense_activation_silu__decode_kernel
.p2align 8
.type sequential_preLN__sliding_block_cached__dense_activation_silu__decode_kernel,@function
sequential_preLN__sliding_block_cached__dense_activation_silu__decode_kernel:
    s_load_dwordx8 s[4:11], s[0:1], 0
    s_cmpk_ge_u32 s2, 256
    s_cbranch_scc1 L_end
    v_readfirstlane_b32 s3, v0
    v_and_b32 v0, 63, v0
    s_lshr_b32 s3, s3, 6
    s_lshr_b32 s26, s2, 5
    s_and_b32 s27, s2, 31
    s_cmp_ge_u32 s2, 8
    s_cbranch_scc1 L_nopf0
    s_getpc_b64 s[56:57]
L_pc0:
    s_lshl_b32 s84, s3, 13
    v_lshl_add_u32 v34, v0, 7, s84
    v_min_u32 v34, L_codeend-L_pc0-4, v34
    global_load_dword v34, v34, s[56:57]
L_nopf0:
    v_min_u32 v33, 59, v0
    v_mul_u32_u24 v32, 21846, v33
    v_lshrrev_b32 v32, 16, v32
    v_mul_u32_u24 v32, 11904, v32
    v_lshl_add_u32 v33, v33, 7, v32
    s_lshl2_add_u32 s99, s26, s3
    s_mul_i32 s99, s99, 245760
    s_mul_i32 s96, s27, 384
    s_sub_u32 s42, 7864320, s96
    s_mov_b32 s43, 0x20000
    v_lshrrev_b32 v55, 3, v0
    v_and_b32 v56, 7, v0
    v_lshlrev_b32 v53, 2, v0
    s_lshl_b32 s94, s3, 3
    v_xor_b32 v54, s94, v53
    v_and_b32 v57, 32, v0
    v_bfe_u32 v58, v0, 3, 1
    v_bfe_u32 v59, v0, 4, 1
    v_lshl_add_u32 v60, v58, 4, v57
    v_add_u32 v60, v60, v59
    v_mul_u32_u24 v60, 12288, v60
    v_lshl_add_u32 v3, v56, 4, v60
    s_waitcnt lgkmcnt(0)
    s_add_u32 s40, s10, s96
    s_addc_u32 s41, s11, 0
    buffer_load_dword v32, v33, s[40:43], s99 offen
L_first:
    s_load_dwordx8 s[12:19], s[0:1], 32
    s_load_dwordx4 s[20:23], s[0:1], 64
    s_load_dwordx2 s[24:25], s[0:1], 80
    v_lshrrev_b32 v60, 4, v0
    v_mul_u32_u24 v60, 384, v60
    v_lshl_add_u32 v1, v56, 4, v60
    s_mul_i32 s94, s2, 1572864
    s_add_u32 s94, s94, 1179648
    s_mul_i32 s95, s26, 1280
    s_mul_i32 s86, s3, 1572864
    s_mul_i32 s97, s2, 5
    s_add_u32 s97, s97, s3
    s_mov_b32 s80, 0
    s_mov_b32 s81, 0
    s_mov_b32 s82, 0
    s_mov_b32 s83, 0
    s_mul_i32 s90, s3, 36864
    s_add_u32 s90, s90, 5120
    s_mov_b32 s85, s26
    s_add_u32 s71, s97, 0
    s_and_b32 s71, s71, 63
    s_lshl1_add_u32 s71, s71, 0
    s_mul_i32 s78, s71, 1536
    s_mov_b32 s68, 66048
    s_cmp_ge_u32 s71, 43
    s_cselect_b32 s70, 66048, 0
    s_add_u32 s78, s78, s70
    s_cmp_ge_u32 s71, 86
    s_cselect_b32 s68, 64512, s68
    s_cselect_b32 s70, 66048, 0
    s_add_u32 s78, s78, s70
    s_sub_u32 s70, s68, s81
    s_mov_b32 s81, s68
    s_mov_b32 exec_lo, 0xff00ff00
    s_mov_b32 exec_hi, 0xff00ff00
    v_add_u32 v1, s70, v1
    s_mov_b64 exec, -1
    s_mov_b32 s30, 1280
    s_mov_b32 s31, 0x20000
    s_mov_b32 s34, 393216
    s_mov_b32 s35, 0x20000
    s_add_u32 s28, s4, s95
    s_addc_u32 s29, s5, 0
    s_add_u32 s32, s6, s94
    s_addc_u32 s33, s7, 0
    s_add_u32 m0, s90, 0
    s_nop 0
    buffer_load_dwordx4 v1, s[32:35], s78 offen offset:0 nt lds
    s_add_u32 m0, s90, 896
    s_nop 0
    buffer_load_dwordx4 v1, s[32:35], s78 offen offset:128 nt lds
    s_add_u32 m0, s90, 1792
    s_nop 0
    buffer_load_dwordx4 v1, s[32:35], s78 offen offset:256 nt lds
    s_add_u32 s71, s97, 0
    s_and_b32 s71, s71, 63
    s_lshl1_add_u32 s71, s71, 1
    s_mul_i32 s78, s71, 1536
    s_mov_b32 s68, 66048
    s_cmp_ge_u32 s71, 43
    s_cselect_b32 s70, 66048, 0
    s_add_u32 s78, s78, s70
    s_cmp_ge_u32 s71, 86
    s_cselect_b32 s68, 64512, s68
    s_cselect_b32 s70, 66048, 0
    s_add_u32 s78, s78, s70
    s_sub_u32 s70, s68, s81
    s_mov_b32 s81, s68
    s_mov_b32 exec_lo, 0xff00ff00
    s_mov_b32 exec_hi, 0xff00ff00
    v_add_u32 v1, s70, v1
    s_mov_b64 exec, -1
    s_add_u32 s84, s3, 0
    s_and_b32 s84, s84, 3
    s_lshl_b32 s84, s84, 8
    buffer_load_dword v48, v53, s[28:31], s84 offen
    s_add_u32 s84, s3, 1
    s_and_b32 s84, s84, 3
    s_lshl_b32 s84, s84, 8
    buffer_load_dword v49, v53, s[28:31], s84 offen
    s_add_u32 s84, s3, 2
    s_and_b32 s84, s84, 3
    s_lshl_b32 s84, s84, 8
    buffer_load_dword v50, v53, s[28:31], s84 offen
    s_add_u32 s84, s3, 3
    s_and_b32 s84, s84, 3
    s_lshl_b32 s84, s84, 8
    buffer_load_dword v51, v53, s[28:31], s84 offen
    buffer_load_dword v52, v54, s[28:31], 0 offen offset:1024
    s_add_u32 m0, s90, 3072
    s_nop 0
    buffer_load_dwordx4 v1, s[32:35], s78 offen offset:0 nt lds
    s_add_u32 m0, s90, 3968
    s_nop 0
    buffer_load_dwordx4 v1, s[32:35], s78 offen offset:128 nt lds
    s_add_u32 m0, s90, 4864
    s_nop 0
    buffer_load_dwordx4 v1, s[32:35], s78 offen offset:256 nt lds
    s_add_u32 s71, s97, 4
    s_and_b32 s71, s71, 63
    s_lshl1_add_u32 s71, s71, 0
    s_mul_i32 s78, s71, 1536
    s_mov_b32 s68, 66048
    s_cmp_ge_u32 s71, 43
    s_cselect_b32 s70, 66048, 0
    s_add_u32 s78, s78, s70
    s_cmp_ge_u32 s71, 86
    s_cselect_b32 s68, 64512, s68
    s_cselect_b32 s70, 66048, 0
    s_add_u32 s78, s78, s70
    s_sub_u32 s70, s68, s81
    s_mov_b32 s81, s68
    s_mov_b32 exec_lo, 0xff00ff00
    s_mov_b32 exec_hi, 0xff00ff00
    v_add_u32 v1, s70, v1
    s_mov_b64 exec, -1
    s_waitcnt lgkmcnt(0)
    s_add_u32 s36, s8, s94
    s_addc_u32 s37, s9, 0
    s_mov_b32 s38, 393216
    s_mov_b32 s39, 0x20000
    s_add_u32 s56, s20, s95
    s_addc_u32 s57, s21, 0
    s_mov_b32 s58, 1280
    s_mov_b32 s59, 0x20000
    s_mul_i32 s96, s27, 245760
    s_add_u32 s44, s12, s96
    s_addc_u32 s45, s13, 0
    s_mov_b32 s46, 245760
    s_mov_b32 s47, 0x20000
    s_and_b32 s94, s27, 7
    s_lshl_b32 s94, s94, 2
    s_lshr_b32 s95, s27, 3
    s_add_u32 s94, s94, s95
    s_and_b32 s96, s27, 7
    s_mul_i32 s96, s96, 384
    s_add_u32 s48, s16, s96
    s_addc_u32 s49, s17, 0
    s_sub_u32 s50, 1966080, s96
    s_mov_b32 s51, 0x20000
    s_mul_i32 s96, s94, 61440
    s_add_u32 s52, s18, s96
    s_addc_u32 s53, s19, 0
    s_mov_b32 s54, 61440
    s_mov_b32 s55, 0x20000
    s_mov_b32 s60, s22
    s_mov_b32 s61, s23
    s_mov_b32 s62, 256
    s_mov_b32 s63, 0x20000
    s_mov_b32 s64, s24
    s_mov_b32 s65, s25
    s_mov_b32 s66, 0x1000000
    s_mov_b32 s67, 0x20000
    s_lshl_b32 s94, s3, 2
    s_add_u32 s94, s94, 512
    s_mul_i32 s87, s94, 12288
    s_mul_i32 s88, s3, 393216
    s_and_b32 s94, s3, 1
    s_lshl_b32 s94, s94, 5
    s_lshr_b32 s95, s3, 1
    s_add_u32 s94, s94, s95
    s_add_u32 s94, s94, 512
    s_mul_i32 s89, s94, 3072
    s_sub_u32 s94, 8, s3
    s_lshl_b32 s94, s94, 7
    s_cmp_lt_u32 s3, 2
    s_cselect_b32 s1, s94, 0x100000
    s_mov_b32 s92, 0x01010101
    s_mov_b32 s93, 0x01010101
    s_lshr_b32 s98, s2, 3
    s_cmp_eq_u32 s3, 0
    s_cselect_b32 s98, s98, 64
    v_mul_u32_u24 v60, 12, v57
    v_lshl_add_u32 v2, v56, 4, v60
    v_lshrrev_b32 v60, 4, v0
    s_mul_i32 s94, s3, 16
    v_add_u32 v60, s94, v60
    v_mul_u32_u24 v60, 1280, v60
    v_and_b32 v4, 15, v0
    v_lshl_add_u32 v4, v4, 4, v60
    v_lshrrev_b32 v60, 3, v57
    v_lshl_add_u32 v60, v58, 1, v60
    v_lshl_add_u32 v6, v59, 3, v60
    v_mul_u32_u24 v6, 3072, v6
    v_min_u32 v5, 5, v56
    v_lshl_add_u32 v6, v5, 4, v6
    s_lshr_b32 s94, s27, 3
    s_mul_i32 s94, s94, 96
    v_add_u32 v6, s94, v6
    v_add_u32 v60, v60, v59
    v_mul_u32_u24 v60, 1280, v60
    v_lshl_add_u32 v60, v56, 4, v60
    s_lshl_b32 s94, s3, 8
    v_add_u32 v5, s94, v60
    v_cmp_gt_u32 vcc, 4, v56
    v_mov_b32 v60, 0xffff
    v_and_b32 v7, 3, v56
    v_cndmask_b32 v8, 0, v60, vcc
    v_mul_u32_u24 v7, 0x5555, v7
    v_xor_b32 v9, v60, v8
    v_lshlrev_b32 v10, 16, v8
    v_lshlrev_b32 v11, 16, v9
    v_lshrrev_b32 v60, 5, v0
    v_lshl_add_u32 v60, v58, 1, v60
    v_lshl_add_u32 v60, v59, 2, v60
    v_lshl_add_u32 v60, v56, 3, v60
    s_lshl_b32 s94, s3, 2
    v_lshl_add_u32 v63, v60, 4, s94
    v_mov_b32 v60, 1073741824
    s_lshl_b32 s94, s26, 15
    s_lshl_b32 s95, s27, 7
    s_add_u32 s94, s94, s95
    s_add_u32 s94, s94, 1572864
    s_cmp_eq_u32 s3, 3
    s_cselect_b32 s95, 64, 0
    v_and_b32 v61, 31, v0
    v_lshl_add_u32 v61, v61, 2, s94
    v_lshl_add_u32 v61, v57, 7, v61
    v_cmp_gt_u32 vcc, s95, v0
    s_nop 1
    v_cndmask_b32 v61, v60, v61, vcc
    s_mov_b32 s0, 0
    s_add_u32 m0, s90, 6144
    s_nop 0
    buffer_load_dwordx4 v1, s[32:35], s78 offen offset:0 nt lds
    s_cmp_lg_u32 s85, 0
    s_cbranch_scc1 L_skip0
    s_call_b64 s[100:101], L_burst_wq
L_skip0:
    s_add_u32 m0, s90, 7040
    s_nop 0
    buffer_load_dwordx4 v1, s[32:35], s78 offen offset:128 nt lds
    s_waitcnt vmcnt(11)
    s_add_u32 m0, s90, 7936
    s_nop 0
    buffer_load_dwordx4 v1, s[32:35], s78 offen offset:256 nt lds
    s_add_u32 s71, s97, 4
    s_and_b32 s71, s71, 63
    s_lshl1_add_u32 s71, s71, 1
    s_mul_i32 s78, s71, 1536
    s_mov_b32 s68, 66048
    s_cmp_ge_u32 s71, 43
    s_cselect_b32 s70, 66048, 0
    s_add_u32 s78, s78, s70
    s_cmp_ge_u32 s71, 86
    s_cselect_b32 s68, 64512, s68
    s_cselect_b32 s70, 66048, 0
    s_add_u32 s78, s78, s70
    s_sub_u32 s70, s68, s81
    s_mov_b32 s81, s68
    s_mov_b32 exec_lo, 0xff00ff00
    s_mov_b32 exec_hi, 0xff00ff00
    v_add_u32 v1, s70, v1
    s_mov_b64 exec, -1
    s_waitcnt vmcnt(11)
    s_add_u32 m0, s90, 9216
    s_nop 0
    buffer_load_dwordx4 v1, s[32:35], s78 offen offset:0 nt lds
    s_waitcnt vmcnt(11)
    s_add_u32 m0, s90, 10112
    s_nop 0
    buffer_load_dwordx4 v1, s[32:35], s78 offen offset:128 nt lds
    s_waitcnt vmcnt(11)
    s_add_u32 m0, s90, 11008
    s_nop 0
    buffer_load_dwordx4 v1, s[32:35], s78 offen offset:256 nt lds
    s_add_u32 s71, s97, 8
    s_and_b32 s71, s71, 63
    s_lshl1_add_u32 s71, s71, 0
    s_mul_i32 s78, s71, 1536
    s_mov_b32 s68, 66048
    s_cmp_ge_u32 s71, 43
    s_cselect_b32 s70, 66048, 0
    s_add_u32 s78, s78, s70
    s_cmp_ge_u32 s71, 86
    s_cselect_b32 s68, 64512, s68
    s_cselect_b32 s70, 66048, 0
    s_add_u32 s78, s78, s70
    s_sub_u32 s70, s68, s81
    s_mov_b32 s81, s68
    s_mov_b32 exec_lo, 0xff00ff00
    s_mov_b32 exec_hi, 0xff00ff00
    v_add_u32 v1, s70, v1
    s_mov_b64 exec, -1
    s_waitcnt vmcnt(11)
    s_add_u32 m0, s90, 12288
    s_nop 0
    buffer_load_dwordx4 v1, s[32:35], s78 offen offset:0 nt lds
    s_waitcnt vmcnt(11)
    s_add_u32 m0, s90, 13184
    s_nop 0
    buffer_load_dwordx4 v1, s[32:35], s78 offen offset:128 nt lds
    s_waitcnt vmcnt(11)
    s_add_u32 m0, s90, 14080
    s_nop 0
    buffer_load_dwordx4 v1, s[32:35], s78 offen offset:256 nt lds
    s_add_u32 s71, s97, 8
    s_and_b32 s71, s71, 63
    s_lshl1_add_u32 s71, s71, 1
    s_mul_i32 s78, s71, 1536
    s_mov_b32 s68, 66048
    s_cmp_ge_u32 s71, 43
    s_cselect_b32 s70, 66048, 0
    s_add_u32 s78, s78, s70
    s_cmp_ge_u32 s71, 86
    s_cselect_b32 s68, 64512, s68
    s_cselect_b32 s70, 66048, 0
    s_add_u32 s78, s78, s70
    s_sub_u32 s70, s68, s81
    s_mov_b32 s81, s68
    s_mov_b32 exec_lo, 0xff00ff00
    s_mov_b32 exec_hi, 0xff00ff00
    v_add_u32 v1, s70, v1
    s_mov_b64 exec, -1
    v_lshlrev_b32 v20, 16, v48
    v_and_b32 v21, 0xffff0000, v48
    v_lshlrev_b32 v22, 16, v49
    v_and_b32 v23, 0xffff0000, v49
    v_lshlrev_b32 v24, 16, v50
    v_and_b32 v25, 0xffff0000, v50
    v_lshlrev_b32 v26, 16, v51
    v_and_b32 v27, 0xffff0000, v51
    v_lshlrev_b32 v28, 16, v52
    v_and_b32 v29, 0xffff0000, v52
    v_pk_add_f32 v[48:49], v[20:21], v[22:23]
    v_pk_add_f32 v[50:51], v[24:25], v[26:27]
    v_pk_add_f32 v[48:49], v[48:49], v[28:29]
    v_pk_add_f32 v[48:49], v[48:49], v[50:51]
    v_add_f32 v48, v48, v49
    v_mov_b32 v50, 0xbacccccd
    s_nop 0
    v_add_f32_dpp v48, v48, v48 quad_perm:[1,0,3,2] row_mask:0xf bank_mask:0xf
    s_nop 1
    v_add_f32_dpp v48, v48, v48 quad_perm:[2,3,0,1] row_mask:0xf bank_mask:0xf
    s_nop 1
    v_add_f32_dpp v48, v48, v48 row_half_mirror row_mask:0xf bank_mask:0xf
    s_nop 1
    v_add_f32_dpp v48, v48, v48 row_mirror row_mask:0xf bank_mask:0xf
    s_nop 1
    v_add_f32_dpp v48, v48, v48 row_bcast:15 row_mask:0xa bank_mask:0xf
    s_nop 1
    v_add_f32_dpp v48, v48, v48 row_bcast:31 row_mask:0xc bank_mask:0xf
    s_nop 0
    v_readlane_b32 s94, v48, 63
    s_nop 1
    v_mul_f32 v48, s94, v50
    v_mul_f32 v49, s94, v50
    v_pk_add_f32 v[50:51], v[20:21], v[48:49]
    v_pk_add_f32 v[22:23], v[22:23], v[48:49]
    v_pk_mul_f32 v[50:51], v[50:51], v[50:51]
    v_pk_add_f32 v[24:25], v[24:25], v[48:49]
    v_pk_fma_f32 v[50:51], v[22:23], v[22:23], v[50:51]
    v_pk_add_f32 v[26:27], v[26:27], v[48:49]
    v_pk_fma_f32 v[50:51], v[24:25], v[24:25], v[50:51]
    v_pk_add_f32 v[22:23], v[28:29], v[48:49]
    v_pk_fma_f32 v[50:51], v[26:27], v[26:27], v[50:51]
    v_pk_fma_f32 v[50:51], v[22:23], v[22:23], v[50:51]
    v_add_f32 v50, v50, v51
    v_cvt_pk_bf16_f32 v48, v48, v48
    v_lshlrev_b32 v49, 16, v48
    v_add_f32_dpp v50, v50, v50 quad_perm:[1,0,3,2] row_mask:0xf bank_mask:0xf
    v_lshlrev_b32 v48, 16, v48
    v_pk_add_f32 v[20:21], v[20:21], v[48:49]
    v_add_f32_dpp v50, v50, v50 quad_perm:[2,3,0,1] row_mask:0xf bank_mask:0xf
    v_pk_add_f32 v[28:29], v[28:29], v[48:49]
    v_cvt_pk_bf16_f32 v22, v20, v21
    v_add_f32_dpp v50, v50, v50 row_half_mirror row_mask:0xf bank_mask:0xf
    v_cvt_pk_bf16_f32 v23, v28, v29
    v_lshlrev_b32 v20, 16, v22
    v_add_f32_dpp v50, v50, v50 row_mirror row_mask:0xf bank_mask:0xf
    v_and_b32 v21, 0xffff0000, v22
    v_lshlrev_b32 v28, 16, v23
    v_add_f32_dpp v50, v50, v50 row_bcast:15 row_mask:0xa bank_mask:0xf
    v_and_b32 v29, 0xffff0000, v23
    v_mov_b32 v52, 0x3acccccd
    v_add_f32_dpp v50, v50, v50 row_bcast:31 row_mask:0xc bank_mask:0xf
    s_nop 0
    v_readlane_b32 s94, v50, 63
    s_nop 1
    v_mul_f32 v48, s94, v52
    v_cvt_pk_bf16_f32 v48, v48, v48
    v_lshlrev_b32 v48, 16, v48
    v_add_f32 v48, 0x3727c5ac, v48
    v_cvt_pk_bf16_f32 v48, v48, v48
    v_lshlrev_b32 v48, 16, v48
    v_sqrt_f32 v48, v48
    s_nop 0
    v_cvt_pk_bf16_f32 v48, v48, v48
    v_lshlrev_b32 v48, 16, v48
    v_rcp_f32 v48, v48
    s_nop 0
    v_mul_f32 v20, v20, v48
    v_mul_f32 v21, v21, v48
    v_cvt_pk_bf16_f32 v44, v20, v21
    v_mul_f32 v28, v28, v48
    v_mul_f32 v29, v29, v48
    v_mov_b32_dpp v45, v44 row_half_mirror row_mask:0xf bank_mask:0xf
    v_cvt_pk_bf16_f32 v46, v28, v29
    s_nop 1
    v_mov_b32_dpp v47, v46 row_half_mirror row_mask:0xf bank_mask:0xf
    v_mov_b32 v20, 0
    v_mov_b32 v21, 0
    v_mov_b32 v22, 0
    v_mov_b32 v23, 0
    v_mov_b32 v24, 0
    v_mov_b32 v25, 0
    v_mov_b32 v26, 0
    v_mov_b32 v27, 0
    v_mov_b32 v28, 0
    v_mov_b32 v29, 0
    v_mov_b32 v30, 0
    v_mov_b32 v31, 0
    s_waitcnt vmcnt(11)
    s_cmp_lg_u32 s85, 1
    s_cbranch_scc1 L_skip1
    s_call_b64 s[100:101], L_burst_wq
L_skip1:
    s_add_u32 m0, s90, 15360
    s_nop 0
    buffer_load_dwordx4 v1, s[32:35], s78 offen offset:0 nt lds
    s_waitcnt vmcnt(11)
    s_add_u32 m0, s90, 16256
    s_nop 0
    buffer_load_dwordx4 v1, s[32:35], s78 offen offset:128 nt lds
    s_waitcnt vmcnt(11)
    s_add_u32 m0, s90, 17152
    s_nop 0
    buffer_load_dwordx4 v1, s[32:35], s78 offen offset:256 nt lds
    s_add_u32 s71, s97, 12
    s_and_b32 s71, s71, 63
    s_lshl1_add_u32 s71, s71, 0
    s_mul_i32 s78, s71, 1536
    s_mov_b32 s68, 66048
    s_cmp_ge_u32 s71, 43
    s_cselect_b32 s70, 66048, 0
    s_add_u32 s78, s78, s70
    s_cmp_ge_u32 s71, 86
    s_cselect_b32 s68, 64512, s68
    s_cselect_b32 s70, 66048, 0
    s_add_u32 s78, s78, s70
    s_sub_u32 s70, s68, s81
    s_mov_b32 s81, s68
    s_mov_b32 exec_lo, 0xff00ff00
    s_mov_b32 exec_hi, 0xff00ff00
    v_add_u32 v1, s70, v1
    s_mov_b64 exec, -1
    s_waitcnt vmcnt(11)
    s_add_u32 m0, s90, 18432
    s_nop 0
    buffer_load_dwordx4 v1, s[32:35], s78 offen offset:0 nt lds
    s_waitcnt vmcnt(11)
    s_add_u32 m0, s90, 19328
    s_nop 0
    buffer_load_dwordx4 v1, s[32:35], s78 offen offset:128 nt lds
    s_waitcnt vmcnt(11)
    s_add_u32 m0, s90, 20224
    s_nop 0
    buffer_load_dwordx4 v1, s[32:35], s78 offen offset:256 nt lds
    s_add_u32 s71, s97, 12
    s_and_b32 s71, s71, 63
    s_lshl1_add_u32 s71, s71, 1
    s_mul_i32 s78, s71, 1536
    s_mov_b32 s68, 66048
    s_cmp_ge_u32 s71, 43
    s_cselect_b32 s70, 66048, 0
    s_add_u32 s78, s78, s70
    s_cmp_ge_u32 s71, 86
    s_cselect_b32 s68, 64512, s68
    s_cselect_b32 s70, 66048, 0
    s_add_u32 s78, s78, s70
    s_sub_u32 s70, s68, s81
    s_mov_b32 s81, s68
    s_mov_b32 exec_lo, 0xff00ff00
    s_mov_b32 exec_hi, 0xff00ff00
    v_add_u32 v1, s70, v1
    s_mov_b64 exec, -1
    s_waitcnt vmcnt(11)
    s_add_u32 m0, s90, 21504
    s_nop 0
    buffer_load_dwordx4 v1, s[32:35], s78 offen offset:0 nt lds
    s_waitcnt vmcnt(11)
    s_add_u32 m0, s90, 22400
    s_nop 0
    buffer_load_dwordx4 v1, s[32:35], s78 offen offset:128 nt lds
    s_waitcnt vmcnt(11)
    s_cmp_lg_u32 s85, 2
    s_cbranch_scc1 L_skip2
    s_call_b64 s[100:101], L_burst_wq
L_skip2:
    s_add_u32 m0, s90, 23296
    s_nop 0
    buffer_load_dwordx4 v1, s[32:35], s78 offen offset:256 nt lds
    s_add_u32 s71, s97, 16
    s_and_b32 s71, s71, 63
    s_lshl1_add_u32 s71, s71, 0
    s_mul_i32 s78, s71, 1536
    s_mov_b32 s68, 66048
    s_cmp_ge_u32 s71, 43
    s_cselect_b32 s70, 66048, 0
    s_add_u32 s78, s78, s70
    s_cmp_ge_u32 s71, 86
    s_cselect_b32 s68, 64512, s68
    s_cselect_b32 s70, 66048, 0
    s_add_u32 s78, s78, s70
    s_sub_u32 s70, s68, s81
    s_mov_b32 s81, s68
    s_mov_b32 exec_lo, 0xff00ff00
    s_mov_b32 exec_hi, 0xff00ff00
    v_add_u32 v1, s70, v1
    s_mov_b64 exec, -1
    s_waitcnt vmcnt(11)
    s_cmp_lg_u32 s2, 0
    s_cbranch_scc1 L_noprobe0
    s_lshl_b32 s76, s3, 8
    s_add_u32 s76, s76, 1835008
    s_add_u32 s76, s64, s76
    s_addc_u32 s77, s65, 0
    s_waitcnt lgkmcnt(0)
    s_load_dword s74, s[76:77], 0x0
    s_load_dword s75, s[76:77], 0x2000
    s_waitcnt lgkmcnt(1)
    s_getreg_b32 s73, hwreg(HW_REG_IB_STS, 8, 4)
    s_sub_u32 s0, s0, s73
L_noprobe0:
    s_add_u32 m0, s90, 24576
    s_nop 0
    buffer_load_dwordx4 v1, s[32:35], s78 offen offset:0 nt lds
    s_waitcnt vmcnt(11)
    s_add_u32 m0, s90, 25472
    s_nop 0
    buffer_load_dwordx4 v1, s[32:35], s78 offen offset:128 nt lds
    s_waitcnt vmcnt(11)
    s_add_u32 m0, s90, 26368
    s_nop 0
    buffer_load_dwordx4 v1, s[32:35], s78 offen offset:256 nt lds
    s_add_u32 s71, s97, 16
    s_and_b32 s71, s71, 63
    s_lshl1_add_u32 s71, s71, 1
    s_mul_i32 s78, s71, 1536
    s_mov_b32 s68, 66048
    s_cmp_ge_u32 s71, 43
    s_cselect_b32 s70, 66048, 0
    s_add_u32 s78, s78, s70
    s_cmp_ge_u32 s71, 86
    s_cselect_b32 s68, 64512, s68
    s_cselect_b32 s70, 66048, 0
    s_add_u32 s78, s78, s70
    s_sub_u32 s70, s68, s81
    s_mov_b32 s81, s68
    s_mov_b32 exec_lo, 0xff00ff00
    s_mov_b32 exec_hi, 0xff00ff00
    v_add_u32 v1, s70, v1
    s_mov_b64 exec, -1
    s_waitcnt vmcnt(11)
    s_add_u32 m0, s90, 27648
    s_nop 0
    buffer_load_dwordx4 v1, s[32:35], s78 offen offset:0 nt lds
    s_waitcnt vmcnt(11)
    s_add_u32 m0, s90, 28544
    s_nop 0
    buffer_load_dwordx4 v1, s[32:35], s78 offen offset:128 nt lds
    s_waitcnt vmcnt(11)
    s_add_u32 m0, s90, 29440
    s_nop 0
    buffer_load_dwordx4 v1, s[32:35], s78 offen offset:256 nt lds
    s_add_u32 s71, s97, 20
    s_and_b32 s71, s71, 63
    s_lshl1_add_u32 s71, s71, 0
    s_mul_i32 s78, s71, 1536
    s_mov_b32 s68, 66048
    s_cmp_ge_u32 s71, 43
    s_cselect_b32 s70, 66048, 0
    s_add_u32 s78, s78, s70
    s_cmp_ge_u32 s71, 86
    s_cselect_b32 s68, 64512, s68
    s_cselect_b32 s70, 66048, 0
    s_add_u32 s78, s78, s70
    s_sub_u32 s70, s68, s81
    s_mov_b32 s81, s68
    s_mov_b32 exec_lo, 0xff00ff00
    s_mov_b32 exec_hi, 0xff00ff00
    v_add_u32 v1, s70, v1
    s_mov_b64 exec, -1
    s_waitcnt vmcnt(11)
    s_add_u32 m0, s90, 30720
    s_nop 0
    buffer_load_dwordx4 v1, s[32:35], s78 offen offset:0 nt lds
    s_waitcnt vmcnt(11)
    s_cmp_lg_u32 s85, 3
    s_cbranch_scc1 L_skip3
    s_call_b64 s[100:101], L_burst_wq
L_skip3:
    s_add_u32 m0, s90, 31616
    s_nop 0
    buffer_load_dwordx4 v1, s[32:35], s78 offen offset:128 nt lds
    s_waitcnt vmcnt(11)
    s_add_u32 m0, s90, 32512
    s_nop 0
    buffer_load_dwordx4 v1, s[32:35], s78 offen offset:256 nt lds
    s_add_u32 s71, s97, 20
    s_and_b32 s71, s71, 63
    s_lshl1_add_u32 s71, s71, 1
    s_mul_i32 s78, s71, 1536
    s_mov_b32 s68, 66048
    s_cmp_ge_u32 s71, 43
    s_cselect_b32 s70, 66048, 0
    s_add_u32 s78, s78, s70
    s_cmp_ge_u32 s71, 86
    s_cselect_b32 s68, 64512, s68
    s_cselect_b32 s70, 66048, 0
    s_add_u32 s78, s78, s70
    s_sub_u32 s70, s68, s81
    s_mov_b32 s81, s68
    s_mov_b32 exec_lo, 0xff00ff00
    s_mov_b32 exec_hi, 0xff00ff00
    v_add_u32 v1, s70, v1
    s_mov_b64 exec, -1
    s_waitcnt vmcnt(11)
    s_add_u32 m0, s90, 33792
    s_nop 0
    buffer_load_dwordx4 v1, s[32:35], s78 offen offset:0 nt lds
    s_waitcnt vmcnt(11)
    s_cmp_lg_u32 s2, 0
    s_cbranch_scc1 L_noprobe1
    s_lshl_b32 s76, s3, 8
    s_add_u32 s76, s76, 1836032
    s_add_u32 s76, s64, s76
    s_addc_u32 s77, s65, 0
    s_waitcnt lgkmcnt(0)
    s_load_dword s74, s[76:77], 0x2000
    s_load_dword s75, s[76:77], 0x0
    s_waitcnt lgkmcnt(1)
    s_getreg_b32 s73, hwreg(HW_REG_IB_STS, 8, 4)
    s_add_u32 s0, s0, s73
L_noprobe1:
    s_add_u32 m0, s90, 34688
    s_nop 0
    buffer_load_dwordx4 v1, s[32:35], s78 offen offset:128 nt lds
    s_waitcnt vmcnt(11)
    s_add_u32 m0, s90, 35584
    s_nop 0
    buffer_load_dwordx4 v1, s[32:35], s78 offen offset:256 nt lds
    s_add_u32 s71, s97, 24
    s_and_b32 s71, s71, 63
    s_lshl1_add_u32 s71, s71, 0
    s_mul_i32 s78, s71, 1536
    s_mov_b32 s68, 66048
    s_cmp_ge_u32 s71, 43
    s_cselect_b32 s70, 66048, 0
    s_add_u32 s78, s78, s70
    s_cmp_ge_u32 s71, 86
    s_cselect_b32 s68, 64512, s68
    s_cselect_b32 s70, 66048, 0
    s_add_u32 s78, s78, s70
    s_sub_u32 s70, s68, s81
    s_mov_b32 s81, s68
    s_mov_b32 exec_lo, 0xff00ff00
    s_mov_b32 exec_hi, 0xff00ff00
    v_add_u32 v1, s70, v1
    s_mov_b64 exec, -1
    s_waitcnt vmcnt(11)
    buffer_load_dwordx4 v[248:251], v1, s[32:35], s78 offen offset:0 nt
    s_waitcnt vmcnt(11)
    buffer_load_dwordx4 v[252:255], v1, s[32:35], s78 offen offset:128 nt
    s_waitcnt vmcnt(11)
    buffer_load_dwordx4 v[240:243], v1, s[32:35], s78 offen offset:256 nt
    s_add_u32 s71, s97, 24
    s_and_b32 s71, s71, 63
    s_lshl1_add_u32 s71, s71, 1
    s_mul_i32 s78, s71, 1536
    s_mov_b32 s68, 66048
    s_cmp_ge_u32 s71, 43
    s_cselect_b32 s70, 66048, 0
    s_add_u32 s78, s78, s70
    s_cmp_ge_u32 s71, 86
    s_cselect_b32 s68, 64512, s68
    s_cselect_b32 s70, 66048, 0
    s_add_u32 s78, s78, s70
    s_sub_u32 s70, s68, s81
    s_mov_b32 s81, s68
    s_mov_b32 exec_lo, 0xff00ff00
    s_mov_b32 exec_hi, 0xff00ff00
    v_add_u32 v1, s70, v1
    s_mov_b64 exec, -1
    s_waitcnt vmcnt(11)
    s_cmp_lg_u32 s85, 4
    s_cbranch_scc1 L_skip4
    s_call_b64 s[100:101], L_burst_wq
L_skip4:
    buffer_load_dwordx4 v[244:247], v1, s[32:35], s78 offen offset:0 nt
    s_waitcnt vmcnt(11)
    buffer_load_dwordx4 v[232:235], v1, s[32:35], s78 offen offset:128 nt
    s_waitcnt vmcnt(11)
    buffer_load_dwordx4 v[236:239], v1, s[32:35], s78 offen offset:256 nt
    s_add_u32 s71, s97, 28
    s_and_b32 s71, s71, 63
    s_lshl1_add_u32 s71, s71, 0
    s_mul_i32 s78, s71, 1536
    s_mov_b32 s68, 66048
    s_cmp_ge_u32 s71, 43
    s_cselect_b32 s70, 66048, 0
    s_add_u32 s78, s78, s70
    s_cmp_ge_u32 s71, 86
    s_cselect_b32 s68, 64512, s68
    s_cselect_b32 s70, 66048, 0
    s_add_u32 s78, s78, s70
    s_sub_u32 s70, s68, s81
    s_mov_b32 s81, s68
    s_mov_b32 exec_lo, 0xff00ff00
    s_mov_b32 exec_hi, 0xff00ff00
    v_add_u32 v1, s70, v1
    s_mov_b64 exec, -1
    s_waitcnt vmcnt(11)
    buffer_load_dwordx4 v[224:227], v1, s[32:35], s78 offen offset:0 nt
    s_waitcnt vmcnt(11)
    buffer_load_dwordx4 v[228:231], v1, s[32:35], s78 offen offset:128 nt
    s_waitcnt vmcnt(11)
    s_cmp_lg_u32 s2, 0
    s_cbranch_scc1 L_noprobe2
    s_lshl_b32 s76, s3, 8
    s_add_u32 s76, s76, 1837056
    s_add_u32 s76, s64, s76
    s_addc_u32 s77, s65, 0
    s_waitcnt lgkmcnt(0)
    s_load_dword s74, s[76:77], 0x0
    s_load_dword s75, s[76:77], 0x2000
    s_waitcnt lgkmcnt(1)
    s_getreg_b32 s73, hwreg(HW_REG_IB_STS, 8, 4)
    s_sub_u32 s0, s0, s73
L_noprobe2:
    buffer_load_dwordx4 v[216:219], v1, s[32:35], s78 offen offset:256 nt
    s_add_u32 s71, s97, 28
    s_and_b32 s71, s71, 63
    s_lshl1_add_u32 s71, s71, 1
    s_mul_i32 s78, s71, 1536
    s_mov_b32 s68, 66048
    s_cmp_ge_u32 s71, 43
    s_cselect_b32 s70, 66048, 0
    s_add_u32 s78, s78, s70
    s_cmp_ge_u32 s71, 86
    s_cselect_b32 s68, 64512, s68
    s_cselect_b32 s70, 66048, 0
    s_add_u32 s78, s78, s70
    s_sub_u32 s70, s68, s81
    s_mov_b32 s81, s68
    s_mov_b32 exec_lo, 0xff00ff00
    s_mov_b32 exec_hi, 0xff00ff00
    v_add_u32 v1, s70, v1
    s_mov_b64 exec, -1
    s_waitcnt vmcnt(11)
    buffer_load_dwordx4 v[220:223], v1, s[32:35], s78 offen offset:0 nt
    s_waitcnt vmcnt(11)
    buffer_load_dwordx4 v[208:211], v1, s[32:35], s78 offen offset:128 nt
    s_waitcnt vmcnt(11)
    s_cmp_lg_u32 s85, 5
    s_cbranch_scc1 L_skip5
    s_call_b64 s[100:101], L_burst_wq
L_skip5:
    buffer_load_dwordx4 v[212:215], v1, s[32:35], s78 offen offset:256 nt
    s_add_u32 s71, s97, 32
    s_and_b32 s71, s71, 63
    s_lshl1_add_u32 s71, s71, 0
    s_mul_i32 s78, s71, 1536
    s_mov_b32 s68, 66048
    s_cmp_ge_u32 s71, 43
    s_cselect_b32 s70, 66048, 0
    s_add_u32 s78, s78, s70
    s_cmp_ge_u32 s71, 86
    s_cselect_b32 s68, 64512, s68
    s_cselect_b32 s70, 66048, 0
    s_add_u32 s78, s78, s70
    s_sub_u32 s70, s68, s81
    s_mov_b32 s81, s68
    s_mov_b32 exec_lo, 0xff00ff00
    s_mov_b32 exec_hi, 0xff00ff00
    v_add_u32 v1, s70, v1
    s_mov_b64 exec, -1
    s_waitcnt vmcnt(11)
    buffer_load_dwordx4 v[200:203], v1, s[32:35], s78 offen offset:0 nt
    s_waitcnt vmcnt(11)
    buffer_load_dwordx4 v[204:207], v1, s[32:35], s78 offen offset:128 nt
    s_waitcnt vmcnt(11)
    buffer_load_dwordx4 v[192:195], v1, s[32:35], s78 offen offset:256 nt
    s_add_u32 s71, s97, 32
    s_and_b32 s71, s71, 63
    s_lshl1_add_u32 s71, s71, 1
    s_mul_i32 s78, s71, 1536
    s_mov_b32 s68, 66048
    s_cmp_ge_u32 s71, 43
    s_cselect_b32 s70, 66048, 0
    s_add_u32 s78, s78, s70
    s_cmp_ge_u32 s71, 86
    s_cselect_b32 s68, 64512, s68
    s_cselect_b32 s70, 66048, 0
    s_add_u32 s78, s78, s70
    s_sub_u32 s70, s68, s81
    s_mov_b32 s81, s68
    s_mov_b32 exec_lo, 0xff00ff00
    s_mov_b32 exec_hi, 0xff00ff00
    v_add_u32 v1, s70, v1
    s_mov_b64 exec, -1
    s_waitcnt vmcnt(11)
    buffer_load_dwordx4 v[196:199], v1, s[32:35], s78 offen offset:0 nt
    s_waitcnt vmcnt(11)
    buffer_load_dwordx4 v[184:187], v1, s[32:35], s78 offen offset:128 nt
    s_waitcnt vmcnt(11)
    buffer_load_dwordx4 v[188:191], v1, s[32:35], s78 offen offset:256 nt
    s_add_u32 s71, s97, 36
    s_and_b32 s71, s71, 63
    s_lshl1_add_u32 s71, s71, 0
    s_mul_i32 s78, s71, 1536
    s_mov_b32 s68, 66048
    s_cmp_ge_u32 s71, 43
    s_cselect_b32 s70, 66048, 0
    s_add_u32 s78, s78, s70
    s_cmp_ge_u32 s71, 86
    s_cselect_b32 s68, 64512, s68
    s_cselect_b32 s70, 66048, 0
    s_add_u32 s78, s78, s70
    s_sub_u32 s70, s68, s81
    s_mov_b32 s81, s68
    s_mov_b32 exec_lo, 0xff00ff00
    s_mov_b32 exec_hi, 0xff00ff00
    v_add_u32 v1, s70, v1
    s_mov_b64 exec, -1
    s_waitcnt vmcnt(11)
    s_cmp_lg_u32 s2, 0
    s_cbranch_scc1 L_noprobe3
    s_lshl_b32 s76, s3, 8
    s_add_u32 s76, s76, 1838080
    s_add_u32 s76, s64, s76
    s_addc_u32 s77, s65, 0
    s_waitcnt lgkmcnt(0)
    s_load_dword s74, s[76:77], 0x2000
    s_load_dword s75, s[76:77], 0x0
    s_waitcnt lgkmcnt(1)
    s_getreg_b32 s73, hwreg(HW_REG_IB_STS, 8, 4)
    s_add_u32 s0, s0, s73
L_noprobe3:
    buffer_load_dwordx4 v[176:179], v1, s[32:35], s78 offen offset:0 nt
    s_waitcnt vmcnt(11)
    s_cmp_lg_u32 s85, 6
    s_cbranch_scc1 L_skip6
    s_call_b64 s[100:101], L_burst_wq
L_skip6:
    buffer_load_dwordx4 v[180:183], v1, s[32:35], s78 offen offset:128 nt
    s_waitcnt vmcnt(11)
    buffer_load_dwordx4 v[168:171], v1, s[32:35], s78 offen offset:256 nt
    s_add_u32 s71, s97, 36
    s_and_b32 s71, s71, 63
    s_lshl1_add_u32 s71, s71, 1
    s_mul_i32 s78, s71, 1536
    s_mov_b32 s68, 66048
    s_cmp_ge_u32 s71, 43
    s_cselect_b32 s70, 66048, 0
    s_add_u32 s78, s78, s70
    s_cmp_ge_u32 s71, 86
    s_cselect_b32 s68, 64512, s68
    s_cselect_b32 s70, 66048, 0
    s_add_u32 s78, s78, s70
    s_sub_u32 s70, s68, s81
    s_mov_b32 s81, s68
    s_mov_b32 exec_lo, 0xff00ff00
    s_mov_b32 exec_hi, 0xff00ff00
    v_add_u32 v1, s70, v1
    s_mov_b64 exec, -1
    s_waitcnt vmcnt(11)
    buffer_load_dwordx4 v[172:175], v1, s[32:35], s78 offen offset:0 nt
    s_waitcnt vmcnt(11)
    buffer_load_dwordx4 v[160:163], v1, s[32:35], s78 offen offset:128 nt
    s_waitcnt vmcnt(11)
    buffer_load_dwordx4 v[164:167], v1, s[32:35], s78 offen offset:256 nt
    s_add_u32 s71, s97, 40
    s_and_b32 s71, s71, 63
    s_lshl1_add_u32 s71, s71, 0
    s_mul_i32 s78, s71, 1536
    s_mov_b32 s68, 66048
    s_cmp_ge_u32 s71, 43
    s_cselect_b32 s70, 66048, 0
    s_add_u32 s78, s78, s70
    s_cmp_ge_u32 s71, 86
    s_cselect_b32 s68, 64512, s68
    s_cselect_b32 s70, 66048, 0
    s_add_u32 s78, s78, s70
    s_sub_u32 s70, s68, s81
    s_mov_b32 s81, s68
    s_mov_b32 exec_lo, 0xff00ff00
    s_mov_b32 exec_hi, 0xff00ff00
    v_add_u32 v1, s70, v1
    s_mov_b64 exec, -1
    s_waitcnt vmcnt(11)
    buffer_load_dwordx4 v[152:155], v1, s[32:35], s78 offen offset:0 nt
    s_waitcnt vmcnt(11)
    buffer_load_dwordx4 v[156:159], v1, s[32:35], s78 offen offset:128 nt
    s_waitcnt vmcnt(11)
    buffer_load_dwordx4 v[144:147], v1, s[32:35], s78 offen offset:256 nt
    s_add_u32 s71, s97, 40
    s_and_b32 s71, s71, 63
    s_lshl1_add_u32 s71, s71, 1
    s_mul_i32 s78, s71, 1536
    s_mov_b32 s68, 66048
    s_cmp_ge_u32 s71, 43
    s_cselect_b32 s70, 66048, 0
    s_add_u32 s78, s78, s70
    s_cmp_ge_u32 s71, 86
    s_cselect_b32 s68, 64512, s68
    s_cselect_b32 s70, 66048, 0
    s_add_u32 s78, s78, s70
    s_sub_u32 s70, s68, s81
    s_mov_b32 s81, s68
    s_mov_b32 exec_lo, 0xff00ff00
    s_mov_b32 exec_hi, 0xff00ff00
    v_add_u32 v1, s70, v1
    s_mov_b64 exec, -1
    s_waitcnt vmcnt(11)
    s_cmp_lg_u32 s85, 7
    s_cbranch_scc1 L_skip7
    s_call_b64 s[100:101], L_burst_wq
L_skip7:
    buffer_load_dwordx4 v[148:151], v1, s[32:35], s78 offen offset:0 nt
    s_waitcnt vmcnt(11)
    buffer_load_dwordx4 v[136:139], v1, s[32:35], s78 offen offset:128 nt
    s_waitcnt vmcnt(11)
    buffer_load_dwordx4 v[140:143], v1, s[32:35], s78 offen offset:256 nt
    s_add_u32 s71, s97, 44
    s_and_b32 s71, s71, 63
    s_lshl1_add_u32 s71, s71, 0
    s_mul_i32 s78, s71, 1536
    s_mov_b32 s68, 66048
    s_cmp_ge_u32 s71, 43
    s_cselect_b32 s70, 66048, 0
    s_add_u32 s78, s78, s70
    s_cmp_ge_u32 s71, 86
    s_cselect_b32 s68, 64512, s68
    s_cselect_b32 s70, 66048, 0
    s_add_u32 s78, s78, s70
    s_sub_u32 s70, s68, s81
    s_mov_b32 s81, s68
    s_mov_b32 exec_lo, 0xff00ff00
    s_mov_b32 exec_hi, 0xff00ff00
    v_add_u32 v1, s70, v1
    s_mov_b64 exec, -1
    s_waitcnt vmcnt(11)
    buffer_load_dwordx4 v[128:131], v1, s[32:35], s78 offen offset:0 nt
    s_waitcnt vmcnt(11)
    buffer_load_dwordx4 v[132:135], v1, s[32:35], s78 offen offset:128 nt
    s_waitcnt vmcnt(11)
    buffer_load_dwordx4 v[120:123], v1, s[32:35], s78 offen offset:256 nt
    s_add_u32 s71, s97, 44
    s_and_b32 s71, s71, 63
    s_lshl1_add_u32 s71, s71, 1
    s_mul_i32 s78, s71, 1536
    s_mov_b32 s68, 66048
    s_cmp_ge_u32 s71, 43
    s_cselect_b32 s70, 66048, 0
    s_add_u32 s78, s78, s70
    s_cmp_ge_u32 s71, 86
    s_cselect_b32 s68, 64512, s68
    s_cselect_b32 s70, 66048, 0
    s_add_u32 s78, s78, s70
    s_sub_u32 s70, s68, s81
    s_mov_b32 s81, s68
    s_mov_b32 exec_lo, 0xff00ff00
    s_mov_b32 exec_hi, 0xff00ff00
    v_add_u32 v1, s70, v1
    s_mov_b64 exec, -1
    s_waitcnt vmcnt(11)
    buffer_load_dwordx4 v[124:127], v1, s[32:35], s78 offen offset:0 nt
    s_waitcnt vmcnt(11)
    buffer_load_dwordx4 v[112:115], v1, s[32:35], s78 offen offset:128 nt
    s_waitcnt vmcnt(11)
    s_lshl_b32 s91, s26, 2
    s_add_u32 s91, s91, s3
    s_mul_i32 s91, s91, 7680
    v_lshlrev_b32 v59, 7, v0
    s_mov_b32 exec_lo, 0x7fff
    s_mov_b32 exec_hi, 0x0
    buffer_load_dword v60, v59, s[44:47], s91 offen
    s_mov_b64 exec, -1
    buffer_load_dwordx4 v[116:119], v1, s[32:35], s78 offen offset:256 nt
    s_add_u32 s71, s97, 48
    s_and_b32 s71, s71, 63
    s_lshl1_add_u32 s71, s71, 0
    s_mul_i32 s78, s71, 1536
    s_mov_b32 s68, 66048
    s_cmp_ge_u32 s71, 43
    s_cselect_b32 s70, 66048, 0
    s_add_u32 s78, s78, s70
    s_cmp_ge_u32 s71, 86
    s_cselect_b32 s68, 64512, s68
    s_cselect_b32 s70, 66048, 0
    s_add_u32 s78, s78, s70
    s_sub_u32 s70, s68, s81
    s_mov_b32 s81, s68
    s_mov_b32 exec_lo, 0xff00ff00
    s_mov_b32 exec_hi, 0xff00ff00
    v_add_u32 v1, s70, v1
    s_mov_b64 exec, -1
    s_waitcnt vmcnt(11)
    buffer_load_dwordx4 v[104:107], v1, s[32:35], s78 offen offset:0 nt
    s_waitcnt vmcnt(11)
    buffer_load_dwordx4 v[108:111], v1, s[32:35], s78 offen offset:128 nt
    s_waitcnt vmcnt(11)
    s_lshl_b32 s91, s26, 2
    s_add_u32 s91, s91, s3
    s_mul_i32 s91, s91, 7680
    v_lshlrev_b32 v59, 7, v0
    s_mov_b32 exec_lo, 0x3fff8000
    s_mov_b32 exec_hi, 0x0
    buffer_load_dword v60, v59, s[44:47], s91 offen
    s_mov_b64 exec, -1
    buffer_load_dwordx4 v[96:99], v1, s[32:35], s78 offen offset:256 nt
    s_add_u32 s71, s97, 48
    s_and_b32 s71, s71, 63
    s_lshl1_add_u32 s71, s71, 1
    s_mul_i32 s78, s71, 1536
    s_mov_b32 s68, 66048
    s_cmp_ge_u32 s71, 43
    s_cselect_b32 s70, 66048, 0
    s_add_u32 s78, s78, s70
    s_cmp_ge_u32 s71, 86
    s_cselect_b32 s68, 64512, s68
    s_cselect_b32 s70, 66048, 0
    s_add_u32 s78, s78, s70
    s_sub_u32 s70, s68, s81
    s_mov_b32 s81, s68
    s_mov_b32 exec_lo, 0xff00ff00
    s_mov_b32 exec_hi, 0xff00ff00
    v_add_u32 v1, s70, v1
    s_mov_b64 exec, -1
    s_waitcnt vmcnt(11)
    buffer_load_dwordx4 v[100:103], v1, s[32:35], s78 offen offset:0 nt
    v_and_b32_dpp v12, v44, v8 quad_perm:[0,0,0,0] row_mask:0xf bank_mask:0xf
    v_and_b32_dpp v13, v45, v9 quad_perm:[3,3,3,3] row_mask:0xf bank_mask:0xf
    v_and_b32_dpp v14, v44, v10 quad_perm:[0,0,0,0] row_mask:0xf bank_mask:0xf
    v_and_b32_dpp v15, v45, v11 quad_perm:[3,3,3,3] row_mask:0xf bank_mask:0xf
    s_nop 1
    v_smfmac_f32_16x16x64_bf16 v[20:23], v[12:15], a[0:7], v7
    v_smfmac_f32_16x16x64_bf16 v[24:27], v[12:15], a[8:15], v7
    v_smfmac_f32_16x16x64_bf16 v[28:31], v[12:15], a[16:23], v7
    v_and_b32_dpp v16, v44, v8 quad_perm:[1,1,1,1] row_mask:0xf bank_mask:0xf
    v_and_b32_dpp v17, v45, v9 quad_perm:[2,2,2,2] row_mask:0xf bank_mask:0xf
    v_and_b32_dpp v18, v44, v10 quad_perm:[1,1,1,1] row_mask:0xf bank_mask:0xf
    v_and_b32_dpp v19, v45, v11 quad_perm:[2,2,2,2] row_mask:0xf bank_mask:0xf
    s_nop 1
    v_smfmac_f32_16x16x64_bf16 v[20:23], v[16:19], a[24:31], v7
    v_smfmac_f32_16x16x64_bf16 v[24:27], v[16:19], a[32:39], v7
    s_waitcnt vmcnt(11)
    buffer_load_dwordx4 v[88:91], v1, s[32:35], s78 offen offset:128 nt
    v_smfmac_f32_16x16x64_bf16 v[28:31], v[16:19], a[40:47], v7
    v_and_b32_dpp v12, v44, v8 quad_perm:[2,2,2,2] row_mask:0xf bank_mask:0xf
    v_and_b32_dpp v13, v45, v9 quad_perm:[1,1,1,1] row_mask:0xf bank_mask:0xf
    v_and_b32_dpp v14, v44, v10 quad_perm:[2,2,2,2] row_mask:0xf bank_mask:0xf
    v_and_b32_dpp v15, v45, v11 quad_perm:[1,1,1,1] row_mask:0xf bank_mask:0xf
    s_nop 1
    v_smfmac_f32_16x16x64_bf16 v[20:23], v[12:15], a[48:55], v7
    v_smfmac_f32_16x16x64_bf16 v[24:27], v[12:15], a[56:63], v7
    v_smfmac_f32_16x16x64_bf16 v[28:31], v[12:15], a[64:71], v7
    v_and_b32_dpp v16, v44, v8 quad_perm:[3,3,3,3] row_mask:0xf bank_mask:0xf
    v_and_b32_dpp v17, v45, v9 quad_perm:[0,0,0,0] row_mask:0xf bank_mask:0xf
    v_and_b32_dpp v18, v44, v10 quad_perm:[3,3,3,3] row_mask:0xf bank_mask:0xf
    v_and_b32_dpp v19, v45, v11 quad_perm:[0,0,0,0] row_mask:0xf bank_mask:0xf
    s_nop 1
    v_smfmac_f32_16x16x64_bf16 v[20:23], v[16:19], a[72:79], v7
    s_waitcnt vmcnt(11)
    s_lshl_b32 s91, s26, 2
    s_add_u32 s91, s91, s3
    s_mul_i32 s91, s91, 7680
    v_lshlrev_b32 v59, 7, v0
    s_mov_b32 exec_lo, 0xc0000000
    s_mov_b32 exec_hi, 0x1fff
    buffer_load_dword v60, v59, s[44:47], s91 offen
    s_mov_b64 exec, -1
    buffer_load_dwordx4 v[92:95], v1, s[32:35], s78 offen offset:256 nt
    s_add_u32 s71, s97, 52
    s_and_b32 s71, s71, 63
    s_lshl1_add_u32 s71, s71, 0
    s_mul_i32 s78, s71, 1536
    s_mov_b32 s68, 66048
    s_cmp_ge_u32 s71, 43
    s_cselect_b32 s70, 66048, 0
    s_add_u32 s78, s78, s70
    s_cmp_ge_u32 s71, 86
    s_cselect_b32 s68, 64512, s68
    s_cselect_b32 s70, 66048, 0
    s_add_u32 s78, s78, s70
    s_sub_u32 s70, s68, s81
    s_mov_b32 s81, s68
    s_mov_b32 exec_lo, 0xff00ff00
    s_mov_b32 exec_hi, 0xff00ff00
    v_add_u32 v1, s70, v1
    s_mov_b64 exec, -1
    v_smfmac_f32_16x16x64_bf16 v[24:27], v[16:19], a[80:87], v7
    v_smfmac_f32_16x16x64_bf16 v[28:31], v[16:19], a[88:95], v7
    v_and_b32_dpp v12, v45, v8 quad_perm:[3,3,3,3] row_mask:0xf bank_mask:0xf
    v_and_b32_dpp v13, v44, v9 quad_perm:[0,0,0,0] row_mask:0xf bank_mask:0xf
    v_and_b32_dpp v14, v45, v10 quad_perm:[3,3,3,3] row_mask:0xf bank_mask:0xf
    v_and_b32_dpp v15, v44, v11 quad_perm:[0,0,0,0] row_mask:0xf bank_mask:0xf
    s_nop 1
    v_smfmac_f32_16x16x64_bf16 v[20:23], v[12:15], a[96:103], v7
    v_smfmac_f32_16x16x64_bf16 v[24:27], v[12:15], a[104:111], v7
    v_smfmac_f32_16x16x64_bf16 v[28:31], v[12:15], a[112:119], v7
    s_waitcnt vmcnt(11)
    buffer_load_dwordx4 v[80:83], v1, s[32:35], s78 offen offset:0 nt
    v_and_b32_dpp v16, v45, v8 quad_perm:[2,2,2,2] row_mask:0xf bank_mask:0xf
    v_and_b32_dpp v17, v44, v9 quad_perm:[1,1,1,1] row_mask:0xf bank_mask:0xf
    v_and_b32_dpp v18, v45, v10 quad_perm:[2,2,2,2] row_mask:0xf bank_mask:0xf
    v_and_b32_dpp v19, v44, v11 quad_perm:[1,1,1,1] row_mask:0xf bank_mask:0xf
    s_nop 1
    v_smfmac_f32_16x16x64_bf16 v[20:23], v[16:19], a[120:127], v7
    v_smfmac_f32_16x16x64_bf16 v[24:27], v[16:19], a[128:135], v7
    v_smfmac_f32_16x16x64_bf16 v[28:31], v[16:19], a[136:143], v7
    v_and_b32_dpp v12, v45, v8 quad_perm:[1,1,1,1] row_mask:0xf bank_mask:0xf
    v_and_b32_dpp v13, v44, v9 quad_perm:[2,2,2,2] row_mask:0xf bank_mask:0xf
    v_and_b32_dpp v14, v45, v10 quad_perm:[1,1,1,1] row_mask:0xf bank_mask:0xf
    v_and_b32_dpp v15, v44, v11 quad_perm:[2,2,2,2] row_mask:0xf bank_mask:0xf
    s_nop 1
    v_smfmac_f32_16x16x64_bf16 v[20:23], v[12:15], a[144:151], v7
    v_smfmac_f32_16x16x64_bf16 v[24:27], v[12:15], a[152:159], v7
    s_waitcnt vmcnt(11)
    buffer_load_dwordx4 v[84:87], v1, s[32:35], s78 offen offset:128 nt
    v_smfmac_f32_16x16x64_bf16 v[28:31], v[12:15], a[160:167], v7
    v_and_b32_dpp v16, v45, v8 quad_perm:[0,0,0,0] row_mask:0xf bank_mask:0xf
    v_and_b32_dpp v17, v44, v9 quad_perm:[3,3,3,3] row_mask:0xf bank_mask:0xf
    v_and_b32_dpp v18, v45, v10 quad_perm:[0,0,0,0] row_mask:0xf bank_mask:0xf
    v_and_b32_dpp v19, v44, v11 quad_perm:[3,3,3,3] row_mask:0xf bank_mask:0xf
    s_nop 1
    v_smfmac_f32_16x16x64_bf16 v[20:23], v[16:19], a[168:175], v7
    v_smfmac_f32_16x16x64_bf16 v[24:27], v[16:19], a[176:183], v7
    v_smfmac_f32_16x16x64_bf16 v[28:31], v[16:19], a[184:191], v7
    v_and_b32_dpp v12, v46, v8 quad_perm:[0,0,0,0] row_mask:0xf bank_mask:0xf
    v_and_b32_dpp v13, v47, v9 quad_perm:[3,3,3,3] row_mask:0xf bank_mask:0xf
    v_and_b32_dpp v14, v46, v10 quad_perm:[0,0,0,0] row_mask:0xf bank_mask:0xf
    v_and_b32_dpp v15, v47, v11 quad_perm:[3,3,3,3] row_mask:0xf bank_mask:0xf
    s_nop 1
    v_smfmac_f32_16x16x64_bf16 v[20:23], v[12:15], a[192:199], v7
    s_waitcnt vmcnt(11)
    s_lshl_b32 s91, s26, 2
    s_add_u32 s91, s91, s3
    s_mul_i32 s91, s91, 7680
    v_lshlrev_b32 v59, 7, v0
    s_mov_b32 exec_lo, 0x0
    s_mov_b32 exec_hi, 0xfffe000
    buffer_load_dword v60, v59, s[44:47], s91 offen
    s_mov_b64 exec, -1
    buffer_load_dwordx4 v[72:75], v1, s[32:35], s78 offen offset:256 nt
    s_add_u32 s71, s97, 52
    s_and_b32 s71, s71, 63
    s_lshl1_add_u32 s71, s71, 1
    s_mul_i32 s78, s71, 1536
    s_mov_b32 s68, 66048
    s_cmp_ge_u32 s71, 43
    s_cselect_b32 s70, 66048, 0
    s_add_u32 s78, s78, s70
    s_cmp_ge_u32 s71, 86
    s_cselect_b32 s68, 64512, s68
    s_cselect_b32 s70, 66048, 0
    s_add_u32 s78, s78, s70
    s_sub_u32 s70, s68, s81
    s_mov_b32 s81, s68
    s_mov_b32 exec_lo, 0xff00ff00
    s_mov_b32 exec_hi, 0xff00ff00
    v_add_u32 v1, s70, v1
    s_mov_b64 exec, -1
    v_smfmac_f32_16x16x64_bf16 v[24:27], v[12:15], a[200:207], v7
    v_smfmac_f32_16x16x64_bf16 v[28:31], v[12:15], a[208:215], v7
    v_and_b32_dpp v16, v46, v8 quad_perm:[1,1,1,1] row_mask:0xf bank_mask:0xf
    v_and_b32_dpp v17, v47, v9 quad_perm:[2,2,2,2] row_mask:0xf bank_mask:0xf
    v_and_b32_dpp v18, v46, v10 quad_perm:[1,1,1,1] row_mask:0xf bank_mask:0xf
    v_and_b32_dpp v19, v47, v11 quad_perm:[2,2,2,2] row_mask:0xf bank_mask:0xf
    s_nop 1
    v_smfmac_f32_16x16x64_bf16 v[20:23], v[16:19], a[216:223], v7
    v_smfmac_f32_16x16x64_bf16 v[24:27], v[16:19], a[224:231], v7
    v_smfmac_f32_16x16x64_bf16 v[28:31], v[16:19], a[232:239], v7
    s_waitcnt vmcnt(11)
    buffer_load_dwordx4 v[76:79], v1, s[32:35], s78 offen offset:0 nt
    s_nop 3
    v_permlane32_swap_b32 v20, v21
    v_permlane32_swap_b32 v22, v23
    v_permlane32_swap_b32 v24, v25
    v_permlane32_swap_b32 v26, v27
    v_permlane32_swap_b32 v28, v29
    v_permlane32_swap_b32 v30, v31
    v_add_f32_dpp v20, v21, v20 row_ror:8 row_mask:0xf bank_mask:0x3
    v_add_f32_dpp v24, v25, v24 row_ror:8 row_mask:0xf bank_mask:0x3
    v_add_f32_dpp v28, v29, v28 row_ror:8 row_mask:0xf bank_mask:0x3
    v_add_f32_dpp v20, v22, v23 row_ror:8 row_mask:0xf bank_mask:0xc
    v_add_f32_dpp v24, v26, v27 row_ror:8 row_mask:0xf bank_mask:0xc
    v_add_f32_dpp v28, v30, v31 row_ror:8 row_mask:0xf bank_mask:0xc
    ds_write_b32 v63, v20 offset:0
    ds_write_b32 v63, v24 offset:1024
    ds_write_b32 v63, v28 offset:2048
    v_lshlrev_b32 v48, 4, v0
    s_mul_i32 s94, s3, 384
    v_lshl_add_u32 v49, v0, 1, s94
    v_and_b32 v50, 7, v0
    v_lshl_add_u32 v50, v50, 4, s94
    s_lshl_b32 s94, s3, 2
    v_mov_b32 v52, s94
    v_mov_b32 v53, s0
    ds_write_b32 v52, v53 offset:4640
    s_waitcnt lgkmcnt(0)
    s_barrier
    s_or_b32 s94, s2, s3
    s_cbranch_scc1 L_nononce
    ds_read_b128 v[12:15], v52 offset:4640
    s_memrealtime s[76:77]
    s_waitcnt lgkmcnt(0)
    s_mul_i32 s94, s76, 0x9e3779b1
    s_max_u32 s94, s94, 1
    v_add3_u32 v12, v12, v13, v14
    v_add_u32 v12, v12, v15
    v_cmp_lt_i32 vcc, 0, v12
    s_getreg_b32 s95, hwreg(HW_REG_XCC_ID, 0, 3)
    v_mov_b32 v12, s94
    s_lshr_b32 s94, s95, 1
    s_and_b32 s94, s94, 2
    s_lshl4_add_u32 s94, s95, s94
    v_cndmask_b32 v13, 0, 2, vcc
    v_xor_b32 v13, s94, v13
    s_mov_b64 exec, 1
    buffer_store_dwordx2 v[12:13], off, s[60:63], 0 sc1
    s_mov_b64 exec, -1
L_nononce:
    ds_read_b128 v[20:23], v48 offset:0
    ds_read_b128 v[24:27], v48 offset:1024
    ds_read_b128 v[28:31], v48 offset:2048
    s_waitcnt vmcnt(11)
    buffer_load_dwordx4 v[64:67], v1, s[32:35], s78 offen offset:128 nt
    s_waitcnt lgkmcnt(0)
    v_pk_add_f32 v[20:21], v[20:21], v[22:23]
    v_pk_add_f32 v[24:25], v[24:25], v[26:27]
    v_pk_add_f32 v[28:29], v[28:29], v[30:31]
    v_add_f32 v20, v20, v21
    v_add_f32 v24, v24, v25
    v_add_f32 v28, v28, v29
    v_cvt_pk_bf16_f32 v20, v20, v20
    v_cvt_pk_bf16_f32 v24, v24, v24
    v_cvt_pk_bf16_f32 v28, v28, v28
    ds_write_b16 v49, v20 offset:3072
    ds_write_b16 v49, v24 offset:3200
    ds_write_b16 v49, v28 offset:3328
    s_waitcnt lgkmcnt(0)
    ds_read_b128 v[32:35], v50 offset:3072
    ds_read_b128 v[36:39], v50 offset:3200
    ds_read_b128 v[40:43], v50 offset:3328
    v_mov_b32 v20, 0
    v_mov_b32 v21, 0
    v_mov_b32 v22, 0
    v_mov_b32 v23, 0
    v_mov_b32 v24, 0
    v_mov_b32 v25, 0
    v_mov_b32 v26, 0
    v_mov_b32 v27, 0
    v_mov_b32 v28, 0
    v_mov_b32 v29, 0
    v_mov_b32 v30, 0
    v_mov_b32 v31, 0
    s_waitcnt lgkmcnt(0)
    s_waitcnt vmcnt(11)
    buffer_load_dwordx4 v[68:71], v1, s[32:35], s78 offen offset:256 nt
    s_add_u32 s71, s97, 56
    s_and_b32 s71, s71, 63
    s_lshl1_add_u32 s71, s71, 0
    s_mul_i32 s78, s71, 1536
    s_mov_b32 s68, 66048
    s_cmp_ge_u32 s71, 43
    s_cselect_b32 s70, 66048, 0
    s_add_u32 s78, s78, s70
    s_cmp_ge_u32 s71, 86
    s_cselect_b32 s68, 64512, s68
    s_cselect_b32 s70, 66048, 0
    s_add_u32 s78, s78, s70
    s_sub_u32 s70, s68, s81
    s_mov_b32 s81, s68
    s_mov_b32 exec_lo, 0xff00ff00
    s_mov_b32 exec_hi, 0xff00ff00
    v_add_u32 v1, s70, v1
    s_mov_b64 exec, -1
    v_lshl_add_u32 v51, v0, 4, s90
    v_dot2_f32_bf16 v48, v248, v32, 0
    v_dot2_f32_bf16 v48, v249, v33, v48
    v_dot2_f32_bf16 v48, v250, v34, v48
    v_dot2_f32_bf16 v48, v251, v35, v48
    v_dot2_f32_bf16 v48, v252, v36, v48
    v_dot2_f32_bf16 v48, v253, v37, v48
    v_dot2_f32_bf16 v48, v254, v38, v48
    v_dot2_f32_bf16 v48, v255, v39, v48
    v_dot2_f32_bf16 v48, v240, v40, v48
    v_dot2_f32_bf16 v48, v241, v41, v48
    v_dot2_f32_bf16 v48, v242, v42, v48
    v_dot2_f32_bf16 v48, v243, v43, v48
    v_dot2_f32_bf16 v49, v244, v32, 0
    v_dot2_f32_bf16 v49, v245, v33, v49
    v_dot2_f32_bf16 v49, v246, v34, v49
    v_dot2_f32_bf16 v49, v247, v35, v49
    v_dot2_f32_bf16 v49, v232, v36, v49
    v_dot2_f32_bf16 v49, v233, v37, v49
    v_dot2_f32_bf16 v49, v234, v38, v49
    v_dot2_f32_bf16 v49, v235, v39, v49
    v_dot2_f32_bf16 v49, v236, v40, v49
    v_dot2_f32_bf16 v49, v237, v41, v49
    v_dot2_f32_bf16 v49, v238, v42, v49
    v_dot2_f32_bf16 v49, v239, v43, v49
    s_lshl_b64 vcc, s[92:93], 6
    v_add_f32_dpp v48, v48, v48 quad_perm:[1,0,3,2] row_mask:0xf bank_mask:0xf
    s_nop 0
    v_add_f32_dpp v49, v49, v49 quad_perm:[1,0,3,2] row_mask:0xf bank_mask:0xf
    v_add_f32_dpp v48, v48, v48 quad_perm:[2,3,0,1] row_mask:0xf bank_mask:0xf
    s_nop 0
    v_add_f32_dpp v49, v49, v49 quad_perm:[2,3,0,1] row_mask:0xf bank_mask:0xf
    v_add_f32_dpp v48, v48, v48 row_half_mirror row_mask:0xf bank_mask:0xf
    s_nop 0
    v_add_f32_dpp v49, v49, v49 row_half_mirror row_mask:0xf bank_mask:0xf
    v_cndmask_b32 v44, v44, v48, vcc
    v_cndmask_b32 v45, v45, v49, vcc
    s_waitcnt vmcnt(11)
    buffer_load_dwordx4 v[248:251], v1, s[32:35], s78 offen offset:0 nt
    v_dot2_f32_bf16 v48, v224, v32, 0
    v_dot2_f32_bf16 v48, v225, v33, v48
    v_dot2_f32_bf16 v48, v226, v34, v48
    v_dot2_f32_bf16 v48, v227, v35, v48
    v_dot2_f32_bf16 v48, v228, v36, v48
    v_dot2_f32_bf16 v48, v229, v37, v48
    v_dot2_f32_bf16 v48, v230, v38, v48
    v_dot2_f32_bf16 v48, v231, v39, v48
    v_dot2_f32_bf16 v48, v216, v40, v48
    v_dot2_f32_bf16 v48, v217, v41, v48
    v_dot2_f32_bf16 v48, v218, v42, v48
    v_dot2_f32_bf16 v48, v219, v43, v48
    v_dot2_f32_bf16 v49, v220, v32, 0
    v_dot2_f32_bf16 v49, v221, v33, v49
    v_dot2_f32_bf16 v49, v222, v34, v49
    v_dot2_f32_bf16 v49, v223, v35, v49
    v_dot2_f32_bf16 v49, v208, v36, v49
    v_dot2_f32_bf16 v49, v209, v37, v49
    v_dot2_f32_bf16 v49, v210, v38, v49
    v_dot2_f32_bf16 v49, v211, v39, v49
    v_dot2_f32_bf16 v49, v212, v40, v49
    v_dot2_f32_bf16 v49, v213, v41, v49
    v_dot2_f32_bf16 v49, v214, v42, v49
    v_dot2_f32_bf16 v49, v215, v43, v49
    s_lshl_b64 vcc, s[92:93], 7
    v_add_f32_dpp v48, v48, v48 quad_perm:[1,0,3,2] row_mask:0xf bank_mask:0xf
    s_nop 0
    v_add_f32_dpp v49, v49, v49 quad_perm:[1,0,3,2] row_mask:0xf bank_mask:0xf
    v_add_f32_dpp v48, v48, v48 quad_perm:[2,3,0,1] row_mask:0xf bank_mask:0xf
    s_nop 0
    v_add_f32_dpp v49, v49, v49 quad_perm:[2,3,0,1] row_mask:0xf bank_mask:0xf
    v_add_f32_dpp v48, v48, v48 row_half_mirror row_mask:0xf bank_mask:0xf
    s_nop 0
    v_add_f32_dpp v49, v49, v49 row_half_mirror row_mask:0xf bank_mask:0xf
    v_cndmask_b32 v44, v44, v48, vcc
    v_cndmask_b32 v45, v45, v49, vcc
    s_waitcnt vmcnt(11)
    buffer_load_dwordx4 v[252:255], v1, s[32:35], s78 offen offset:128 nt
    v_dot2_f32_bf16 v48, v200, v32, 0
    v_dot2_f32_bf16 v48, v201, v33, v48
    v_dot2_f32_bf16 v48, v202, v34, v48
    v_dot2_f32_bf16 v48, v203, v35, v48
    v_dot2_f32_bf16 v48, v204, v36, v48
    v_dot2_f32_bf16 v48, v205, v37, v48
    v_dot2_f32_bf16 v48, v206, v38, v48
    v_dot2_f32_bf16 v48, v207, v39, v48
    v_dot2_f32_bf16 v48, v192, v40, v48
    v_dot2_f32_bf16 v48, v193, v41, v48
    v_dot2_f32_bf16 v48, v194, v42, v48
    v_dot2_f32_bf16 v48, v195, v43, v48
    v_dot2_f32_bf16 v49, v196, v32, 0
    v_dot2_f32_bf16 v49, v197, v33, v49
    v_dot2_f32_bf16 v49, v198, v34, v49
    v_dot2_f32_bf16 v49, v199, v35, v49
    v_dot2_f32_bf16 v49, v184, v36, v49
    v_dot2_f32_bf16 v49, v185, v37, v49
    v_dot2_f32_bf16 v49, v186, v38, v49
    v_dot2_f32_bf16 v49, v187, v39, v49
    v_dot2_f32_bf16 v49, v188, v40, v49
    v_dot2_f32_bf16 v49, v189, v41, v49
    v_dot2_f32_bf16 v49, v190, v42, v49
    v_dot2_f32_bf16 v49, v191, v43, v49
    s_lshl_b64 vcc, s[92:93], 0
    v_add_f32_dpp v48, v48, v48 quad_perm:[1,0,3,2] row_mask:0xf bank_mask:0xf
    s_nop 0
    v_add_f32_dpp v49, v49, v49 quad_perm:[1,0,3,2] row_mask:0xf bank_mask:0xf
    v_add_f32_dpp v48, v48, v48 quad_perm:[2,3,0,1] row_mask:0xf bank_mask:0xf
    s_nop 0
    v_add_f32_dpp v49, v49, v49 quad_perm:[2,3,0,1] row_mask:0xf bank_mask:0xf
    v_add_f32_dpp v48, v48, v48 row_half_mirror row_mask:0xf bank_mask:0xf
    s_nop 0
    v_add_f32_dpp v49, v49, v49 row_half_mirror row_mask:0xf bank_mask:0xf
    v_cndmask_b32 v46, v46, v48, vcc
    v_cndmask_b32 v47, v47, v49, vcc
    s_waitcnt vmcnt(11)
    buffer_load_dwordx4 v[240:243], v1, s[32:35], s78 offen offset:256 nt
    s_add_u32 s71, s97, 56
    s_and_b32 s71, s71, 63
    s_lshl1_add_u32 s71, s71, 1
    s_mul_i32 s78, s71, 1536
    s_mov_b32 s68, 66048
    s_cmp_ge_u32 s71, 43
    s_cselect_b32 s70, 66048, 0
    s_add_u32 s78, s78, s70
    s_cmp_ge_u32 s71, 86
    s_cselect_b32 s68, 64512, s68
    s_cselect_b32 s70, 66048, 0
    s_add_u32 s78, s78, s70
    s_sub_u32 s70, s68, s81
    s_mov_b32 s81, s68
    s_mov_b32 exec_lo, 0xff00ff00
    s_mov_b32 exec_hi, 0xff00ff00
    v_add_u32 v1, s70, v1
    s_mov_b64 exec, -1
    v_dot2_f32_bf16 v48, v176, v32, 0
    v_dot2_f32_bf16 v48, v177, v33, v48
    v_dot2_f32_bf16 v48, v178, v34, v48
    v_dot2_f32_bf16 v48, v179, v35, v48
    v_dot2_f32_bf16 v48, v180, v36, v48
    v_dot2_f32_bf16 v48, v181, v37, v48
    v_dot2_f32_bf16 v48, v182, v38, v48
    v_dot2_f32_bf16 v48, v183, v39, v48
    v_dot2_f32_bf16 v48, v168, v40, v48
    v_dot2_f32_bf16 v48, v169, v41, v48
    v_dot2_f32_bf16 v48, v170, v42, v48
    v_dot2_f32_bf16 v48, v171, v43, v48
    ds_read_b128 v[244:247], v51 offset:0
    ds_read_b128 v[168:171], v51 offset:1024
    ds_read_b128 v[232:235], v51 offset:2048
    v_dot2_f32_bf16 v49, v172, v32, 0
    v_dot2_f32_bf16 v49, v173, v33, v49
    v_dot2_f32_bf16 v49, v174, v34, v49
    v_dot2_f32_bf16 v49, v175, v35, v49
    v_dot2_f32_bf16 v49, v160, v36, v49
    v_dot2_f32_bf16 v49, v161, v37, v49
    v_dot2_f32_bf16 v49, v162, v38, v49
    v_dot2_f32_bf16 v49, v163, v39, v49
    v_dot2_f32_bf16 v49, v164, v40, v49
    v_dot2_f32_bf16 v49, v165, v41, v49
    v_dot2_f32_bf16 v49, v166, v42, v49
    v_dot2_f32_bf16 v49, v167, v43, v49
    s_lshl_b64 vcc, s[92:93], 1
    v_add_f32_dpp v48, v48, v48 quad_perm:[1,0,3,2] row_mask:0xf bank_mask:0xf
    s_nop 0
    v_add_f32_dpp v49, v49, v49 quad_perm:[1,0,3,2] row_mask:0xf bank_mask:0xf
    v_add_f32_dpp v48, v48, v48 quad_perm:[2,3,0,1] row_mask:0xf bank_mask:0xf
    s_nop 0
    v_add_f32_dpp v49, v49, v49 quad_perm:[2,3,0,1] row_mask:0xf bank_mask:0xf
    v_add_f32_dpp v48, v48, v48 row_half_mirror row_mask:0xf bank_mask:0xf
    s_nop 0
    v_add_f32_dpp v49, v49, v49 row_half_mirror row_mask:0xf bank_mask:0xf
    v_cndmask_b32 v46, v46, v48, vcc
    v_cndmask_b32 v47, v47, v49, vcc
    s_waitcnt vmcnt(11)
    buffer_load_dwordx4 v[236:239], v1, s[32:35], s78 offen offset:0 nt
    s_waitcnt lgkmcnt(0)
    ds_read_b128 v[172:175], v51 offset:3072
    ds_read_b128 v[224:227], v51 offset:4096
    ds_read_b128 v[228:231], v51 offset:5120
    v_dot2_f32_bf16 v48, v244, v32, 0
    v_dot2_f32_bf16 v48, v245, v33, v48
    v_dot2_f32_bf16 v48, v246, v34, v48
    v_dot2_f32_bf16 v48, v247, v35, v48
    v_dot2_f32_bf16 v48, v168, v36, v48
    v_dot2_f32_bf16 v48, v169, v37, v48
    v_dot2_f32_bf16 v48, v170, v38, v48
    v_dot2_f32_bf16 v48, v171, v39, v48
    v_dot2_f32_bf16 v48, v232, v40, v48
    v_dot2_f32_bf16 v48, v233, v41, v48
    v_dot2_f32_bf16 v48, v234, v42, v48
    v_dot2_f32_bf16 v48, v235, v43, v48
    s_waitcnt lgkmcnt(0)
    ds_read_b128 v[244:247], v51 offset:6144
    ds_read_b128 v[168:171], v51 offset:7168
    ds_read_b128 v[232:235], v51 offset:8192
    v_dot2_f32_bf16 v49, v172, v32, 0
    v_dot2_f32_bf16 v49, v173, v33, v49
    v_dot2_f32_bf16 v49, v174, v34, v49
    v_dot2_f32_bf16 v49, v175, v35, v49
    v_dot2_f32_bf16 v49, v224, v36, v49
    v_dot2_f32_bf16 v49, v225, v37, v49
    v_dot2_f32_bf16 v49, v226, v38, v49
    v_dot2_f32_bf16 v49, v227, v39, v49
    v_dot2_f32_bf16 v49, v228, v40, v49
    v_dot2_f32_bf16 v49, v229, v41, v49
    v_dot2_f32_bf16 v49, v230, v42, v49
    v_dot2_f32_bf16 v49, v231, v43, v49
    s_lshl_b64 vcc, s[92:93], 0
    v_add_f32_dpp v48, v48, v48 quad_perm:[1,0,3,2] row_mask:0xf bank_mask:0xf
    s_nop 0
    v_add_f32_dpp v49, v49, v49 quad_perm:[1,0,3,2] row_mask:0xf bank_mask:0xf
    v_add_f32_dpp v48, v48, v48 quad_perm:[2,3,0,1] row_mask:0xf bank_mask:0xf
    s_nop 0
    v_add_f32_dpp v49, v49, v49 quad_perm:[2,3,0,1] row_mask:0xf bank_mask:0xf
    v_add_f32_dpp v48, v48, v48 row_half_mirror row_mask:0xf bank_mask:0xf
    s_nop 0
    v_add_f32_dpp v49, v49, v49 row_half_mirror row_mask:0xf bank_mask:0xf
    v_cndmask_b32 v44, v44, v48, vcc
    v_cndmask_b32 v45, v45, v49, vcc
    s_waitcnt vmcnt(11)
    buffer_load_dwordx4 v[172:175], v1, s[32:35], s78 offen offset:128 nt
    s_waitcnt lgkmcnt(0)
    ds_read_b128 v[216:219], v51 offset:9216
    ds_read_b128 v[220:223], v51 offset:10240
    ds_read_b128 v[208:211], v51 offset:11264
    v_dot2_f32_bf16 v48, v244, v32, 0
    v_dot2_f32_bf16 v48, v245, v33, v48
    v_dot2_f32_bf16 v48, v246, v34, v48
    v_dot2_f32_bf16 v48, v247, v35, v48
    v_dot2_f32_bf16 v48, v168, v36, v48
    v_dot2_f32_bf16 v48, v169, v37, v48
    v_dot2_f32_bf16 v48, v170, v38, v48
    v_dot2_f32_bf16 v48, v171, v39, v48
    v_dot2_f32_bf16 v48, v232, v40, v48
    v_dot2_f32_bf16 v48, v233, v41, v48
    v_dot2_f32_bf16 v48, v234, v42, v48
    v_dot2_f32_bf16 v48, v235, v43, v48
    s_waitcnt lgkmcnt(0)
    ds_read_b128 v[212:215], v51 offset:12288
    ds_read_b128 v[244:247], v51 offset:13312
    ds_read_b128 v[168:171], v51 offset:14336
    v_dot2_f32_bf16 v49, v216, v32, 0
    v_dot2_f32_bf16 v49, v217, v33, v49
    v_dot2_f32_bf16 v49, v218, v34, v49
    v_dot2_f32_bf16 v49, v219, v35, v49
    v_dot2_f32_bf16 v49, v220, v36, v49
    v_dot2_f32_bf16 v49, v221, v37, v49
    v_dot2_f32_bf16 v49, v222, v38, v49
    v_dot2_f32_bf16 v49, v223, v39, v49
    v_dot2_f32_bf16 v49, v208, v40, v49
    v_dot2_f32_bf16 v49, v209, v41, v49
    v_dot2_f32_bf16 v49, v210, v42, v49
    v_dot2_f32_bf16 v49, v211, v43, v49
    s_lshl_b64 vcc, s[92:93], 1
    v_add_f32_dpp v48, v48, v48 quad_perm:[1,0,3,2] row_mask:0xf bank_mask:0xf
    s_nop 0
    v_add_f32_dpp v49, v49, v49 quad_perm:[1,0,3,2] row_mask:0xf bank_mask:0xf
    v_add_f32_dpp v48, v48, v48 quad_perm:[2,3,0,1] row_mask:0xf bank_mask:0xf
    s_nop 0
    v_add_f32_dpp v49, v49, v49 quad_perm:[2,3,0,1] row_mask:0xf bank_mask:0xf
    v_add_f32_dpp v48, v48, v48 row_half_mirror row_mask:0xf bank_mask:0xf
    s_nop 0
    v_add_f32_dpp v49, v49, v49 row_half_mirror row_mask:0xf bank_mask:0xf
    v_cndmask_b32 v44, v44, v48, vcc
    v_cndmask_b32 v45, v45, v49, vcc
    s_waitcnt vmcnt(11)
    buffer_load_dwordx4 v[232:235], v1, s[32:35], s78 offen offset:256 nt
    s_add_u32 s71, s97, 60
    s_and_b32 s71, s71, 63
    s_lshl1_add_u32 s71, s71, 0
    s_mul_i32 s78, s71, 1536
    s_mov_b32 s68, 66048
    s_cmp_ge_u32 s71, 43
    s_cselect_b32 s70, 66048, 0
    s_add_u32 s78, s78, s70
    s_cmp_ge_u32 s71, 86
    s_cselect_b32 s68, 64512, s68
    s_cselect_b32 s70, 66048, 0
    s_add_u32 s78, s78, s70
    s_sub_u32 s70, s68, s81
    s_mov_b32 s81, s68
    s_mov_b32 exec_lo, 0xff00ff00
    s_mov_b32 exec_hi, 0xff00ff00
    v_add_u32 v1, s70, v1
    s_mov_b64 exec, -1
    s_waitcnt lgkmcnt(0)
    ds_read_b128 v[208:211], v51 offset:15360
    ds_read_b128 v[200:203], v51 offset:16384
    ds_read_b128 v[204:207], v51 offset:17408
    v_dot2_f32_bf16 v48, v212, v32, 0
    v_dot2_f32_bf16 v48, v213, v33, v48
    v_dot2_f32_bf16 v48, v214, v34, v48
    v_dot2_f32_bf16 v48, v215, v35, v48
    v_dot2_f32_bf16 v48, v244, v36, v48
    v_dot2_f32_bf16 v48, v245, v37, v48
    v_dot2_f32_bf16 v48, v246, v38, v48
    v_dot2_f32_bf16 v48, v247, v39, v48
    v_dot2_f32_bf16 v48, v168, v40, v48
    v_dot2_f32_bf16 v48, v169, v41, v48
    v_dot2_f32_bf16 v48, v170, v42, v48
    v_dot2_f32_bf16 v48, v171, v43, v48
    s_waitcnt lgkmcnt(0)
    ds_read_b128 v[212:215], v51 offset:18432
    ds_read_b128 v[244:247], v51 offset:19456
    ds_read_b128 v[168:171], v51 offset:20480
    v_dot2_f32_bf16 v49, v208, v32, 0
    v_dot2_f32_bf16 v49, v209, v33, v49
    v_dot2_f32_bf16 v49, v210, v34, v49
    v_dot2_f32_bf16 v49, v211, v35, v49
    v_dot2_f32_bf16 v49, v200, v36, v49
    v_dot2_f32_bf16 v49, v201, v37, v49
    v_dot2_f32_bf16 v49, v202, v38, v49
    v_dot2_f32_bf16 v49, v203, v39, v49
    v_dot2_f32_bf16 v49, v204, v40, v49
    v_dot2_f32_bf16 v49, v205, v41, v49
    v_dot2_f32_bf16 v49, v206, v42, v49
    v_dot2_f32_bf16 v49, v207, v43, v49
    s_lshl_b64 vcc, s[92:93], 2
    v_add_f32_dpp v48, v48, v48 quad_perm:[1,0,3,2] row_mask:0xf bank_mask:0xf
    s_nop 0
    v_add_f32_dpp v49, v49, v49 quad_perm:[1,0,3,2] row_mask:0xf bank_mask:0xf
    v_add_f32_dpp v48, v48, v48 quad_perm:[2,3,0,1] row_mask:0xf bank_mask:0xf
    s_nop 0
    v_add_f32_dpp v49, v49, v49 quad_perm:[2,3,0,1] row_mask:0xf bank_mask:0xf
    v_add_f32_dpp v48, v48, v48 row_half_mirror row_mask:0xf bank_mask:0xf
    s_nop 0
    v_add_f32_dpp v49, v49, v49 row_half_mirror row_mask:0xf bank_mask:0xf
    v_cndmask_b32 v44, v44, v48, vcc
    v_cndmask_b32 v45, v45, v49, vcc
    s_waitcnt vmcnt(11)
    buffer_load_dwordx4 v[208:211], v1, s[32:35], s78 offen offset:0 nt
    s_waitcnt lgkmcnt(0)
    ds_read_b128 v[192:195], v51 offset:21504
    ds_read_b128 v[196:199], v51 offset:22528
    ds_read_b128 v[184:187], v51 offset:23552
    v_dot2_f32_bf16 v48, v212, v32, 0
    v_dot2_f32_bf16 v48, v213, v33, v48
    v_dot2_f32_bf16 v48, v214, v34, v48
    v_dot2_f32_bf16 v48, v215, v35, v48
    v_dot2_f32_bf16 v48, v244, v36, v48
    v_dot2_f32_bf16 v48, v245, v37, v48
    v_dot2_f32_bf16 v48, v246, v38, v48
    v_dot2_f32_bf16 v48, v247, v39, v48
    v_dot2_f32_bf16 v48, v168, v40, v48
    v_dot2_f32_bf16 v48, v169, v41, v48
    v_dot2_f32_bf16 v48, v170, v42, v48
    v_dot2_f32_bf16 v48, v171, v43, v48
    s_waitcnt lgkmcnt(0)
    ds_read_b128 v[188:191], v51 offset:24576
    ds_read_b128 v[212:215], v51 offset:25600
    ds_read_b128 v[244:247], v51 offset:26624
    v_dot2_f32_bf16 v49, v192, v32, 0
    v_dot2_f32_bf16 v49, v193, v33, v49
    v_dot2_f32_bf16 v49, v194, v34, v49
    v_dot2_f32_bf16 v49, v195, v35, v49
    v_dot2_f32_bf16 v49, v196, v36, v49
    v_dot2_f32_bf16 v49, v197, v37, v49
    v_dot2_f32_bf16 v49, v198, v38, v49
    v_dot2_f32_bf16 v49, v199, v39, v49
    v_dot2_f32_bf16 v49, v184, v40, v49
    v_dot2_f32_bf16 v49, v185, v41, v49
    v_dot2_f32_bf16 v49, v186, v42, v49
    v_dot2_f32_bf16 v49, v187, v43, v49
    s_lshl_b64 vcc, s[92:93], 3
    v_add_f32_dpp v48, v48, v48 quad_perm:[1,0,3,2] row_mask:0xf bank_mask:0xf
    s_nop 0
    v_add_f32_dpp v49, v49, v49 quad_perm:[1,0,3,2] row_mask:0xf bank_mask:0xf
    v_add_f32_dpp v48, v48, v48 quad_perm:[2,3,0,1] row_mask:0xf bank_mask:0xf
    s_nop 0
    v_add_f32_dpp v49, v49, v49 quad_perm:[2,3,0,1] row_mask:0xf bank_mask:0xf
    v_add_f32_dpp v48, v48, v48 row_half_mirror row_mask:0xf bank_mask:0xf
    s_nop 0
    v_add_f32_dpp v49, v49, v49 row_half_mirror row_mask:0xf bank_mask:0xf
    v_cndmask_b32 v44, v44, v48, vcc
    v_cndmask_b32 v45, v45, v49, vcc
    s_waitcnt vmcnt(11)
    buffer_load_dwordx4 v[168:171], v1, s[32:35], s78 offen offset:128 nt
    s_waitcnt lgkmcnt(0)
    ds_read_b128 v[184:187], v51 offset:27648
    ds_read_b128 v[176:179], v51 offset:28672
    ds_read_b128 v[180:183], v51 offset:29696
    v_dot2_f32_bf16 v48, v188, v32, 0
    v_dot2_f32_bf16 v48, v189, v33, v48
    v_dot2_f32_bf16 v48, v190, v34, v48
    v_dot2_f32_bf16 v48, v191, v35, v48
    v_dot2_f32_bf16 v48, v212, v36, v48
    v_dot2_f32_bf16 v48, v213, v37, v48
    v_dot2_f32_bf16 v48, v214, v38, v48
    v_dot2_f32_bf16 v48, v215, v39, v48
    v_dot2_f32_bf16 v48, v244, v40, v48
    v_dot2_f32_bf16 v48, v245, v41, v48
    v_dot2_f32_bf16 v48, v246, v42, v48
    v_dot2_f32_bf16 v48, v247, v43, v48
    s_waitcnt lgkmcnt(0)
    ds_read_b128 v[188:191], v51 offset:30720
    ds_read_b128 v[212:215], v51 offset:31744
    ds_read_b128 v[244:247], v51 offset:32768
    v_dot2_f32_bf16 v49, v184, v32, 0
    v_dot2_f32_bf16 v49, v185, v33, v49
    v_dot2_f32_bf16 v49, v186, v34, v49
    v_dot2_f32_bf16 v49, v187, v35, v49
    v_dot2_f32_bf16 v49, v176, v36, v49
    v_dot2_f32_bf16 v49, v177, v37, v49
    v_dot2_f32_bf16 v49, v178, v38, v49
    v_dot2_f32_bf16 v49, v179, v39, v49
    v_dot2_f32_bf16 v49, v180, v40, v49
    v_dot2_f32_bf16 v49, v181, v41, v49
    v_dot2_f32_bf16 v49, v182, v42, v49
    v_dot2_f32_bf16 v49, v183, v43, v49
    s_lshl_b64 vcc, s[92:93], 4
    v_add_f32_dpp v48, v48, v48 quad_perm:[1,0,3,2] row_mask:0xf bank_mask:0xf
    s_nop 0
    v_add_f32_dpp v49, v49, v49 quad_perm:[1,0,3,2] row_mask:0xf bank_mask:0xf
    v_add_f32_dpp v48, v48, v48 quad_perm:[2,3,0,1] row_mask:0xf bank_mask:0xf
    s_nop 0
    v_add_f32_dpp v49, v49, v49 quad_perm:[2,3,0,1] row_mask:0xf bank_mask:0xf
    v_add_f32_dpp v48, v48, v48 row_half_mirror row_mask:0xf bank_mask:0xf
    s_nop 0
    v_add_f32_dpp v49, v49, v49 row_half_mirror row_mask:0xf bank_mask:0xf
    v_cndmask_b32 v44, v44, v48, vcc
    v_cndmask_b32 v45, v45, v49, vcc
    s_waitcnt vmcnt(11)
    buffer_load_dwordx4 v[184:187], v1, s[32:35], s78 offen offset:256 nt
    s_add_u32 s71, s97, 60
    s_and_b32 s71, s71, 63
    s_lshl1_add_u32 s71, s71, 1
    s_mul_i32 s78, s71, 1536
    s_mov_b32 s68, 66048
    s_cmp_ge_u32 s71, 43
    s_cselect_b32 s70, 66048, 0
    s_add_u32 s78, s78, s70
    s_cmp_ge_u32 s71, 86
    s_cselect_b32 s68, 64512, s68
    s_cselect_b32 s70, 66048, 0
    s_add_u32 s78, s78, s70
    s_sub_u32 s70, s68, s81
    s_mov_b32 s81, s68
    s_mov_b32 exec_lo, 0xff00ff00
    s_mov_b32 exec_hi, 0xff00ff00
    v_add_u32 v1, s70, v1
    s_mov_b64 exec, -1
    s_waitcnt lgkmcnt(0)
    ds_read_b128 v[160:163], v51 offset:33792
    ds_read_b128 v[164:167], v51 offset:34816
    ds_read_b128 v[224:227], v51 offset:35840
    v_dot2_f32_bf16 v48, v188, v32, 0
    v_dot2_f32_bf16 v48, v189, v33, v48
    v_dot2_f32_bf16 v48, v190, v34, v48
    v_dot2_f32_bf16 v48, v191, v35, v48
    v_dot2_f32_bf16 v48, v212, v36, v48
    v_dot2_f32_bf16 v48, v213, v37, v48
    v_dot2_f32_bf16 v48, v214, v38, v48
    v_dot2_f32_bf16 v48, v215, v39, v48
    v_dot2_f32_bf16 v48, v244, v40, v48
    v_dot2_f32_bf16 v48, v245, v41, v48
    v_dot2_f32_bf16 v48, v246, v42, v48
    v_dot2_f32_bf16 v48, v247, v43, v48
    s_waitcnt lgkmcnt(0)
    v_dot2_f32_bf16 v49, v160, v32, 0
    v_dot2_f32_bf16 v49, v161, v33, v49
    v_dot2_f32_bf16 v49, v162, v34, v49
    v_dot2_f32_bf16 v49, v163, v35, v49
    v_dot2_f32_bf16 v49, v164, v36, v49
    v_dot2_f32_bf16 v49, v165, v37, v49
    v_dot2_f32_bf16 v49, v166, v38, v49
    v_dot2_f32_bf16 v49, v167, v39, v49
    v_dot2_f32_bf16 v49, v224, v40, v49
    v_dot2_f32_bf16 v49, v225, v41, v49
    v_dot2_f32_bf16 v49, v226, v42, v49
    v_dot2_f32_bf16 v49, v227, v43, v49
    s_lshl_b64 vcc, s[92:93], 5
    v_add_f32_dpp v48, v48, v48 quad_perm:[1,0,3,2] row_mask:0xf bank_mask:0xf
    s_nop 0
    v_add_f32_dpp v49, v49, v49 quad_perm:[1,0,3,2] row_mask:0xf bank_mask:0xf
    v_add_f32_dpp v48, v48, v48 quad_perm:[2,3,0,1] row_mask:0xf bank_mask:0xf
    s_nop 0
    v_add_f32_dpp v49, v49, v49 quad_perm:[2,3,0,1] row_mask:0xf bank_mask:0xf
    v_add_f32_dpp v48, v48, v48 row_half_mirror row_mask:0xf bank_mask:0xf
    s_nop 0
    v_add_f32_dpp v49, v49, v49 row_half_mirror row_mask:0xf bank_mask:0xf
    v_cndmask_b32 v44, v44, v48, vcc
    v_cndmask_b32 v45, v45, v49, vcc
    s_waitcnt vmcnt(11)
    buffer_load_dwordx4 v[188:191], v1, s[32:35], s78 offen offset:0 nt
    v_dot2_f32_bf16 v48, v152, v32, 0
    v_dot2_f32_bf16 v48, v153, v33, v48
    v_dot2_f32_bf16 v48, v154, v34, v48
    v_dot2_f32_bf16 v48, v155, v35, v48
    v_dot2_f32_bf16 v48, v156, v36, v48
    v_dot2_f32_bf16 v48, v157, v37, v48
    v_dot2_f32_bf16 v48, v158, v38, v48
    v_dot2_f32_bf16 v48, v159, v39, v48
    v_dot2_f32_bf16 v48, v144, v40, v48
    v_dot2_f32_bf16 v48, v145, v41, v48
    v_dot2_f32_bf16 v48, v146, v42, v48
    v_dot2_f32_bf16 v48, v147, v43, v48
    v_dot2_f32_bf16 v49, v148, v32, 0
    v_dot2_f32_bf16 v49, v149, v33, v49
    v_dot2_f32_bf16 v49, v150, v34, v49
    v_dot2_f32_bf16 v49, v151, v35, v49
    v_dot2_f32_bf16 v49, v136, v36, v49
    v_dot2_f32_bf16 v49, v137, v37, v49
    v_dot2_f32_bf16 v49, v138, v38, v49
    v_dot2_f32_bf16 v49, v139, v39, v49
    v_dot2_f32_bf16 v49, v140, v40, v49
    v_dot2_f32_bf16 v49, v141, v41, v49
    v_dot2_f32_bf16 v49, v142, v42, v49
    v_dot2_f32_bf16 v49, v143, v43, v49
    s_lshl_b64 vcc, s[92:93], 2
    v_add_f32_dpp v48, v48, v48 quad_perm:[1,0,3,2] row_mask:0xf bank_mask:0xf
    s_nop 0
    v_add_f32_dpp v49, v49, v49 quad_perm:[1,0,3,2] row_mask:0xf bank_mask:0xf
    v_add_f32_dpp v48, v48, v48 quad_perm:[2,3,0,1] row_mask:0xf bank_mask:0xf
    s_nop 0
    v_add_f32_dpp v49, v49, v49 quad_perm:[2,3,0,1] row_mask:0xf bank_mask:0xf
    v_add_f32_dpp v48, v48, v48 row_half_mirror row_mask:0xf bank_mask:0xf
    s_nop 0
    v_add_f32_dpp v49, v49, v49 row_half_mirror row_mask:0xf bank_mask:0xf
    v_cndmask_b32 v46, v46, v48, vcc
    v_cndmask_b32 v47, v47, v49, vcc
    s_waitcnt vmcnt(11)
    s_cmp_lg_u32 s85, 0
    s_cbranch_scc1 L_skip8
    s_call_b64 s[100:101], L_burst_wo
L_skip8:
    buffer_load_dwordx4 v[212:215], v1, s[32:35], s78 offen offset:128 nt
    v_dot2_f32_bf16 v48, v128, v32, 0
    v_dot2_f32_bf16 v48, v129, v33, v48
    v_dot2_f32_bf16 v48, v130, v34, v48
    v_dot2_f32_bf16 v48, v131, v35, v48
    v_dot2_f32_bf16 v48, v132, v36, v48
    v_dot2_f32_bf16 v48, v133, v37, v48
    v_dot2_f32_bf16 v48, v134, v38, v48
    v_dot2_f32_bf16 v48, v135, v39, v48
    v_dot2_f32_bf16 v48, v120, v40, v48
    v_dot2_f32_bf16 v48, v121, v41, v48
    v_dot2_f32_bf16 v48, v122, v42, v48
    v_dot2_f32_bf16 v48, v123, v43, v48
    v_dot2_f32_bf16 v49, v124, v32, 0
    v_dot2_f32_bf16 v49, v125, v33, v49
    v_dot2_f32_bf16 v49, v126, v34, v49
    v_dot2_f32_bf16 v49, v127, v35, v49
    v_dot2_f32_bf16 v49, v112, v36, v49
    v_dot2_f32_bf16 v49, v113, v37, v49
    v_dot2_f32_bf16 v49, v114, v38, v49
    v_dot2_f32_bf16 v49, v115, v39, v49
    v_dot2_f32_bf16 v49, v116, v40, v49
    v_dot2_f32_bf16 v49, v117, v41, v49
    v_dot2_f32_bf16 v49, v118, v42, v49
    v_dot2_f32_bf16 v49, v119, v43, v49
    s_lshl_b64 vcc, s[92:93], 3
    v_add_f32_dpp v48, v48, v48 quad_perm:[1,0,3,2] row_mask:0xf bank_mask:0xf
    s_nop 0
    v_add_f32_dpp v49, v49, v49 quad_perm:[1,0,3,2] row_mask:0xf bank_mask:0xf
    v_add_f32_dpp v48, v48, v48 quad_perm:[2,3,0,1] row_mask:0xf bank_mask:0xf
    s_nop 0
    v_add_f32_dpp v49, v49, v49 quad_perm:[2,3,0,1] row_mask:0xf bank_mask:0xf
    v_add_f32_dpp v48, v48, v48 row_half_mirror row_mask:0xf bank_mask:0xf
    s_nop 0
    v_add_f32_dpp v49, v49, v49 row_half_mirror row_mask:0xf bank_mask:0xf
    v_cndmask_b32 v46, v46, v48, vcc
    v_cndmask_b32 v47, v47, v49, vcc
    s_waitcnt vmcnt(11)
    buffer_load_dwordx4 v[244:247], v1, s[32:35], s78 offen offset:256 nt
    s_add_u32 s71, s97, 0
    s_and_b32 s71, s71, 63
    s_lshl1_add_u32 s71, s71, 0
    s_mul_i32 s78, s71, 1536
    s_mov_b32 s68, 66048
    s_cmp_ge_u32 s71, 43
    s_cselect_b32 s70, 66048, 0
    s_add_u32 s78, s78, s70
    s_cmp_ge_u32 s71, 86
    s_cselect_b32 s68, 64512, s68
    s_cselect_b32 s70, 66048, 0
    s_add_u32 s78, s78, s70
    s_add_u32 s71, s97, 0
    s_and_b32 s71, s71, 63
    s_lshl1_add_u32 s71, s71, 1
    s_mul_i32 s69, s71, 1536
    s_cmp_ge_u32 s71, 43
    s_cselect_b32 s70, 66048, 0
    s_add_u32 s69, s69, s70
    s_cmp_ge_u32 s71, 86
    s_cselect_b32 s70, 66048, 0
    s_add_u32 s69, s69, s70
    s_sub_u32 s69, s69, s78
    s_sub_u32 s70, s68, s80
    s_mov_b32 s80, s68
    s_mov_b32 exec_lo, 0xff00ff00
    s_mov_b32 exec_hi, 0xff00ff00
    v_add_u32 v2, s70, v2
    s_mov_b64 exec, -1
    s_sub_u32 s70, s69, s82
    s_mov_b32 s82, s69
    s_mov_b32 exec_lo, 0xffff0000
    s_mov_b32 exec_hi, 0xffff0000
    v_add_u32 v2, s70, v2
    s_mov_b64 exec, -1
    v_mov_b32 v1, v2
    s_mov_b32 s81, s80
    s_mov_b32 s83, s82
    s_add_u32 s71, s97, 4
    s_and_b32 s71, s71, 63
    s_lshl1_add_u32 s71, s71, 0
    s_mul_i32 s79, s71, 1536
    s_mov_b32 s68, 66048
    s_cmp_ge_u32 s71, 43
    s_cselect_b32 s70, 66048, 0
    s_add_u32 s79, s79, s70
    s_cmp_ge_u32 s71, 86
    s_cselect_b32 s68, 64512, s68
    s_cselect_b32 s70, 66048, 0
    s_add_u32 s79, s79, s70
    s_add_u32 s71, s97, 4
    s_and_b32 s71, s71, 63
    s_lshl1_add_u32 s71, s71, 1
    s_mul_i32 s69, s71, 1536
    s_cmp_ge_u32 s71, 43
    s_cselect_b32 s70, 66048, 0
    s_add_u32 s69, s69, s70
    s_cmp_ge_u32 s71, 86
    s_cselect_b32 s70, 66048, 0
    s_add_u32 s69, s69, s70
    s_sub_u32 s69, s69, s79
    s_sub_u32 s70, s68, s81
    s_mov_b32 s81, s68
    s_mov_b32 exec_lo, 0xff00ff00
    s_mov_b32 exec_hi, 0xff00ff00
    v_add_u32 v1, s70, v1
    s_mov_b64 exec, -1
    s_sub_u32 s70, s69, s83
    s_mov_b32 s83, s69
    s_mov_b32 exec_lo, 0xffff0000
    s_mov_b32 exec_hi, 0xffff0000
    v_add_u32 v1, s70, v1
    s_mov_b64 exec, -1
    v_dot2_f32_bf16 v48, v104, v32, 0
    v_dot2_f32_bf16 v48, v105, v33, v48
    v_dot2_f32_bf16 v48, v106, v34, v48
    v_dot2_f32_bf16 v48, v107, v35, v48
    v_dot2_f32_bf16 v48, v108, v36, v48
    v_dot2_f32_bf16 v48, v109, v37, v48
    v_dot2_f32_bf16 v48, v110, v38, v48
    v_dot2_f32_bf16 v48, v111, v39, v48
    v_dot2_f32_bf16 v48, v96, v40, v48
    v_dot2_f32_bf16 v48, v97, v41, v48
    v_dot2_f32_bf16 v48, v98, v42, v48
    v_dot2_f32_bf16 v48, v99, v43, v48
    v_dot2_f32_bf16 v49, v100, v32, 0
    v_dot2_f32_bf16 v49, v101, v33, v49
    v_dot2_f32_bf16 v49, v102, v34, v49
    v_dot2_f32_bf16 v49, v103, v35, v49
    v_dot2_f32_bf16 v49, v88, v36, v49
    v_dot2_f32_bf16 v49, v89, v37, v49
    v_dot2_f32_bf16 v49, v90, v38, v49
    v_dot2_f32_bf16 v49, v91, v39, v49
    v_dot2_f32_bf16 v49, v92, v40, v49
    v_dot2_f32_bf16 v49, v93, v41, v49
    v_dot2_f32_bf16 v49, v94, v42, v49
    v_dot2_f32_bf16 v49, v95, v43, v49
    s_lshl_b64 vcc, s[92:93], 4
    v_add_f32_dpp v48, v48, v48 quad_perm:[1,0,3,2] row_mask:0xf bank_mask:0xf
    s_nop 0
    v_add_f32_dpp v49, v49, v49 quad_perm:[1,0,3,2] row_mask:0xf bank_mask:0xf
    v_add_f32_dpp v48, v48, v48 quad_perm:[2,3,0,1] row_mask:0xf bank_mask:0xf
    s_nop 0
    v_add_f32_dpp v49, v49, v49 quad_perm:[2,3,0,1] row_mask:0xf bank_mask:0xf
    v_add_f32_dpp v48, v48, v48 row_half_mirror row_mask:0xf bank_mask:0xf
    s_nop 0
    v_add_f32_dpp v49, v49, v49 row_half_mirror row_mask:0xf bank_mask:0xf
    v_cndmask_b32 v46, v46, v48, vcc
    v_cndmask_b32 v47, v47, v49, vcc
    s_waitcnt vmcnt(11)
    buffer_load_dwordx4 v[224:227], v2, s[36:39], s78 offen offset:0 nt
    v_dot2_f32_bf16 v48, v80, v32, 0
    v_dot2_f32_bf16 v48, v81, v33, v48
    v_dot2_f32_bf16 v48, v82, v34, v48
    v_dot2_f32_bf16 v48, v83, v35, v48
    v_dot2_f32_bf16 v48, v84, v36, v48
    v_dot2_f32_bf16 v48, v85, v37, v48
    v_dot2_f32_bf16 v48, v86, v38, v48
    v_dot2_f32_bf16 v48, v87, v39, v48
    v_dot2_f32_bf16 v48, v72, v40, v48
    v_dot2_f32_bf16 v48, v73, v41, v48
    v_dot2_f32_bf16 v48, v74, v42, v48
    v_dot2_f32_bf16 v48, v75, v43, v48
    v_dot2_f32_bf16 v49, v76, v32, 0
    v_dot2_f32_bf16 v49, v77, v33, v49
    v_dot2_f32_bf16 v49, v78, v34, v49
    v_dot2_f32_bf16 v49, v79, v35, v49
    v_dot2_f32_bf16 v49, v64, v36, v49
    v_dot2_f32_bf16 v49, v65, v37, v49
    v_dot2_f32_bf16 v49, v66, v38, v49
    v_dot2_f32_bf16 v49, v67, v39, v49
    v_dot2_f32_bf16 v49, v68, v40, v49
    v_dot2_f32_bf16 v49, v69, v41, v49
    v_dot2_f32_bf16 v49, v70, v42, v49
    v_dot2_f32_bf16 v49, v71, v43, v49
    s_lshl_b64 vcc, s[92:93], 5
    v_add_f32_dpp v48, v48, v48 quad_perm:[1,0,3,2] row_mask:0xf bank_mask:0xf
    s_nop 0
    v_add_f32_dpp v49, v49, v49 quad_perm:[1,0,3,2] row_mask:0xf bank_mask:0xf
    v_add_f32_dpp v48, v48, v48 quad_perm:[2,3,0,1] row_mask:0xf bank_mask:0xf
    s_nop 0
    v_add_f32_dpp v49, v49, v49 quad_perm:[2,3,0,1] row_mask:0xf bank_mask:0xf
    v_add_f32_dpp v48, v48, v48 row_half_mirror row_mask:0xf bank_mask:0xf
    s_nop 0
    v_add_f32_dpp v49, v49, v49 row_half_mirror row_mask:0xf bank_mask:0xf
    v_cndmask_b32 v46, v46, v48, vcc
    v_cndmask_b32 v47, v47, v49, vcc
    s_waitcnt vmcnt(11)
    buffer_load_dwordx4 v[228:231], v2, s[36:39], s78 offen offset:768 nt
    s_waitcnt vmcnt(11)
    buffer_load_dwordx4 v[216:219], v2, s[36:39], s78 offen offset:128 nt
    v_dot2_f32_bf16 v48, v248, v32, 0
    v_dot2_f32_bf16 v48, v249, v33, v48
    v_dot2_f32_bf16 v48, v250, v34, v48
    v_dot2_f32_bf16 v48, v251, v35, v48
    v_dot2_f32_bf16 v48, v252, v36, v48
    v_dot2_f32_bf16 v48, v253, v37, v48
    v_dot2_f32_bf16 v48, v254, v38, v48
    v_dot2_f32_bf16 v48, v255, v39, v48
    v_dot2_f32_bf16 v48, v240, v40, v48
    v_dot2_f32_bf16 v48, v241, v41, v48
    v_dot2_f32_bf16 v48, v242, v42, v48
    v_dot2_f32_bf16 v48, v243, v43, v48
    s_waitcnt vmcnt(11)
    buffer_load_dwordx4 v[220:223], v2, s[36:39], s78 offen offset:896 nt
    s_waitcnt vmcnt(11)
    buffer_load_dwordx4 v[200:203], v2, s[36:39], s78 offen offset:256 nt
    s_waitcnt vmcnt(11)
    buffer_load_dwordx4 v[204:207], v2, s[36:39], s78 offen offset:1024 nt
    s_add_u32 s71, s97, 8
    s_and_b32 s71, s71, 63
    s_lshl1_add_u32 s71, s71, 0
    s_mul_i32 s78, s71, 1536
    s_mov_b32 s68, 66048
    s_cmp_ge_u32 s71, 43
    s_cselect_b32 s70, 66048, 0
    s_add_u32 s78, s78, s70
    s_cmp_ge_u32 s71, 86
    s_cselect_b32 s68, 64512, s68
    s_cselect_b32 s70, 66048, 0
    s_add_u32 s78, s78, s70
    s_add_u32 s71, s97, 8
    s_and_b32 s71, s71, 63
    s_lshl1_add_u32 s71, s71, 1
    s_mul_i32 s69, s71, 1536
    s_cmp_ge_u32 s71, 43
    s_cselect_b32 s70, 66048, 0
    s_add_u32 s69, s69, s70
    s_cmp_ge_u32 s71, 86
    s_cselect_b32 s70, 66048, 0
    s_add_u32 s69, s69, s70
    s_sub_u32 s69, s69, s78
    s_sub_u32 s70, s68, s80
    s_mov_b32 s80, s68
    s_mov_b32 exec_lo, 0xff00ff00
    s_mov_b32 exec_hi, 0xff00ff00
    v_add_u32 v2, s70, v2
    s_mov_b64 exec, -1
    s_sub_u32 s70, s69, s82
    s_mov_b32 s82, s69
    s_mov_b32 exec_lo, 0xffff0000
    s_mov_b32 exec_hi, 0xffff0000
    v_add_u32 v2, s70, v2
    s_mov_b64 exec, -1
    v_dot2_f32_bf16 v49, v236, v32, 0
    v_dot2_f32_bf16 v49, v237, v33, v49
    v_dot2_f32_bf16 v49, v238, v34, v49
    v_dot2_f32_bf16 v49, v239, v35, v49
    v_dot2_f32_bf16 v49, v172, v36, v49
    v_dot2_f32_bf16 v49, v173, v37, v49
    v_dot2_f32_bf16 v49, v174, v38, v49
    v_dot2_f32_bf16 v49, v175, v39, v49
    v_dot2_f32_bf16 v49, v232, v40, v49
    v_dot2_f32_bf16 v49, v233, v41, v49
    v_dot2_f32_bf16 v49, v234, v42, v49
    v_dot2_f32_bf16 v49, v235, v43, v49
    s_lshl_b64 vcc, s[92:93], 6
    v_add_f32_dpp v48, v48, v48 quad_perm:[1,0,3,2] row_mask:0xf bank_mask:0xf
    s_nop 0
    v_add_f32_dpp v49, v49, v49 quad_perm:[1,0,3,2] row_mask:0xf bank_mask:0xf
    v_add_f32_dpp v48, v48, v48 quad_perm:[2,3,0,1] row_mask:0xf bank_mask:0xf
    s_nop 0
    v_add_f32_dpp v49, v49, v49 quad_perm:[2,3,0,1] row_mask:0xf bank_mask:0xf
    v_add_f32_dpp v48, v48, v48 row_half_mirror row_mask:0xf bank_mask:0xf
    s_nop 0
    v_add_f32_dpp v49, v49, v49 row_half_mirror row_mask:0xf bank_mask:0xf
    v_cndmask_b32 v46, v46, v48, vcc
    v_cndmask_b32 v47, v47, v49, vcc
    s_waitcnt vmcnt(11)
    s_cmp_lg_u32 s85, 1
    s_cbranch_scc1 L_skip9
    s_call_b64 s[100:101], L_burst_wo
L_skip9:
    buffer_load_dwordx4 v[192:195], v1, s[36:39], s79 offen offset:0 nt
    s_waitcnt vmcnt(11)
    buffer_load_dwordx4 v[196:199], v1, s[36:39], s79 offen offset:768 nt
    s_waitcnt vmcnt(11)
    buffer_load_dwordx4 v[176:179], v1, s[36:39], s79 offen offset:128 nt
    v_dot2_f32_bf16 v48, v208, v32, 0
    v_dot2_f32_bf16 v48, v209, v33, v48
    v_dot2_f32_bf16 v48, v210, v34, v48
    v_dot2_f32_bf16 v48, v211, v35, v48
    v_dot2_f32_bf16 v48, v168, v36, v48
    v_dot2_f32_bf16 v48, v169, v37, v48
    v_dot2_f32_bf16 v48, v170, v38, v48
    v_dot2_f32_bf16 v48, v171, v39, v48
    v_dot2_f32_bf16 v48, v184, v40, v48
    v_dot2_f32_bf16 v48, v185, v41, v48
    v_dot2_f32_bf16 v48, v186, v42, v48
    v_dot2_f32_bf16 v48, v187, v43, v48
    s_waitcnt vmcnt(11)
    buffer_load_dwordx4 v[180:183], v1, s[36:39], s79 offen offset:896 nt
    s_waitcnt vmcnt(11)
    buffer_load_dwordx4 v[160:163], v1, s[36:39], s79 offen offset:256 nt
    s_waitcnt vmcnt(11)
    buffer_load_dwordx4 v[164:167], v1, s[36:39], s79 offen offset:1024 nt
    s_add_u32 s71, s97, 12
    s_and_b32 s71, s71, 63
    s_lshl1_add_u32 s71, s71, 0
    s_mul_i32 s79, s71, 1536
    s_mov_b32 s68, 66048
    s_cmp_ge_u32 s71, 43
    s_cselect_b32 s70, 66048, 0
    s_add_u32 s79, s79, s70
    s_cmp_ge_u32 s71, 86
    s_cselect_b32 s68, 64512, s68
    s_cselect_b32 s70, 66048, 0
    s_add_u32 s79, s79, s70
    s_add_u32 s71, s97, 12
    s_and_b32 s71, s71, 63
    s_lshl1_add_u32 s71, s71, 1
    s_mul_i32 s69, s71, 1536
    s_cmp_ge_u32 s71, 43
    s_cselect_b32 s70, 66048, 0
    s_add_u32 s69, s69, s70
    s_cmp_ge_u32 s71, 86
    s_cselect_b32 s70, 66048, 0
    s_add_u32 s69, s69, s70
    s_sub_u32 s69, s69, s79
    s_sub_u32 s70, s68, s81
    s_mov_b32 s81, s68
    s_mov_b32 exec_lo, 0xff00ff00
    s_mov_b32 exec_hi, 0xff00ff00
    v_add_u32 v1, s70, v1
    s_mov_b64 exec, -1
    s_sub_u32 s70, s69, s83
    s_mov_b32 s83, s69
    s_mov_b32 exec_lo, 0xffff0000
    s_mov_b32 exec_hi, 0xffff0000
    v_add_u32 v1, s70, v1
    s_mov_b64 exec, -1
    v_dot2_f32_bf16 v49, v188, v32, 0
    v_dot2_f32_bf16 v49, v189, v33, v49
    v_dot2_f32_bf16 v49, v190, v34, v49
    v_dot2_f32_bf16 v49, v191, v35, v49
    v_dot2_f32_bf16 v49, v212, v36, v49
    v_dot2_f32_bf16 v49, v213, v37, v49
    v_dot2_f32_bf16 v49, v214, v38, v49
    v_dot2_f32_bf16 v49, v215, v39, v49
    v_dot2_f32_bf16 v49, v244, v40, v49
    v_dot2_f32_bf16 v49, v245, v41, v49
    v_dot2_f32_bf16 v49, v246, v42, v49
    v_dot2_f32_bf16 v49, v247, v43, v49
    s_lshl_b64 vcc, s[92:93], 7
    v_add_f32_dpp v48, v48, v48 quad_perm:[1,0,3,2] row_mask:0xf bank_mask:0xf
    s_nop 0
    v_add_f32_dpp v49, v49, v49 quad_perm:[1,0,3,2] row_mask:0xf bank_mask:0xf
    v_add_f32_dpp v48, v48, v48 quad_perm:[2,3,0,1] row_mask:0xf bank_mask:0xf
    s_nop 0
    v_add_f32_dpp v49, v49, v49 quad_perm:[2,3,0,1] row_mask:0xf bank_mask:0xf
    v_add_f32_dpp v48, v48, v48 row_half_mirror row_mask:0xf bank_mask:0xf
    s_nop 0
    v_add_f32_dpp v49, v49, v49 row_half_mirror row_mask:0xf bank_mask:0xf
    v_cndmask_b32 v46, v46, v48, vcc
    v_cndmask_b32 v47, v47, v49, vcc
    v_mov_b32 v52, 0x3d93cd3a
    v_cvt_pk_bf16_f32 v48, v44, v45
    v_cvt_pk_bf16_f32 v49, v46, v47
    v_lshlrev_b32 v44, 16, v48
    v_and_b32 v45, 0xffff0000, v48
    v_lshlrev_b32 v46, 16, v49
    v_and_b32 v47, 0xffff0000, v49
    v_mul_f32 v44, v44, v52
    v_mul_f32 v45, v45, v52
    v_mul_f32 v46, v46, v52
    v_mul_f32 v47, v47, v52
    v_cvt_pk_bf16_f32 v48, v44, v45
    v_cvt_pk_bf16_f32 v49, v46, v47
    v_lshlrev_b32 v44, 16, v48
    v_and_b32 v45, 0xffff0000, v48
    v_lshlrev_b32 v46, 16, v49
    v_and_b32 v47, 0xffff0000, v49
    v_max3_f32 v48, v44, v45, v46
    v_max_f32 v48, v48, v47
    v_mov_b32 v56, 0x3fb8aa3b
    s_lshl_b32 s95, s3, 3
    v_max_f32_dpp v48, v48, v48 quad_perm:[1,0,3,2] row_mask:0xf bank_mask:0xf
    v_mov_b32 v57, s95
    v_mov_b32 v58, 0
    v_max_f32_dpp v48, v48, v48 quad_perm:[2,3,0,1] row_mask:0xf bank_mask:0xf
    s_nop 1
    v_max_f32_dpp v48, v48, v48 row_half_mirror row_mask:0xf bank_mask:0xf
    s_nop 1
    v_max_f32_dpp v48, v48, v48 row_mirror row_mask:0xf bank_mask:0xf
    s_nop 1
    v_max_f32_dpp v48, v48, v48 row_bcast:15 row_mask:0xa bank_mask:0xf
    s_nop 1
    v_max_f32_dpp v48, v48, v48 row_bcast:31 row_mask:0xc bank_mask:0xf
    s_nop 0
    v_readlane_b32 s94, v48, 63
    s_nop 1
    v_subrev_f32 v48, s94, v44
    v_subrev_f32 v49, s94, v45
    v_subrev_f32 v50, s94, v46
    v_subrev_f32 v51, s94, v47
    v_mul_f32 v48, v48, v56
    v_mul_f32 v49, v49, v56
    v_mul_f32 v50, v50, v56
    v_mul_f32 v51, v51, v56
    v_exp_f32 v48, v48
    v_exp_f32 v49, v49
    v_exp_f32 v50, v50
    v_exp_f32 v51, v51
    v_mov_b32 v52, s94
    v_pk_add_f32 v[48:49], v[48:49], v[50:51]
    v_add_f32 v48, v48, v49
    s_nop 1
    v_add_f32_dpp v48, v48, v48 quad_perm:[1,0,3,2] row_mask:0xf bank_mask:0xf
    s_nop 1
    v_add_f32_dpp v48, v48, v48 quad_perm:[2,3,0,1] row_mask:0xf bank_mask:0xf
    s_nop 1
    v_add_f32_dpp v48, v48, v48 row_half_mirror row_mask:0xf bank_mask:0xf
    s_nop 1
    v_add_f32_dpp v48, v48, v48 row_mirror row_mask:0xf bank_mask:0xf
    s_nop 1
    v_add_f32_dpp v48, v48, v48 row_bcast:15 row_mask:0xa bank_mask:0xf
    s_nop 1
    v_add_f32_dpp v48, v48, v48 row_bcast:31 row_mask:0xc bank_mask:0xf
    s_nop 0
    v_readlane_b32 s95, v48, 63
    s_nop 1
    v_mov_b32 v53, s95
    ds_write_b64 v57, v[52:53] offset:4608
    s_waitcnt vmcnt(11)
    buffer_load_dwordx4 v[152:155], v2, s[36:39], s78 offen offset:0 nt
    s_waitcnt lgkmcnt(0)
    s_barrier
    ds_read_b128 v[48:51], v58 offset:4608
    ds_read_b128 v[52:55], v58 offset:4624
    s_waitcnt lgkmcnt(0)
    v_max3_f32 v57, v48, v50, v52
    v_max_f32 v57, v57, v54
    v_sub_f32 v48, v48, v57
    v_sub_f32 v50, v50, v57
    v_sub_f32 v52, v52, v57
    v_sub_f32 v54, v54, v57
    v_sub_f32 v44, v44, v57
    v_sub_f32 v45, v45, v57
    v_sub_f32 v46, v46, v57
    v_sub_f32 v47, v47, v57
    v_mul_f32 v48, v48, v56
    v_mul_f32 v50, v50, v56
    v_mul_f32 v52, v52, v56
    v_mul_f32 v54, v54, v56
    v_mul_f32 v44, v44, v56
    v_mul_f32 v45, v45, v56
    v_mul_f32 v46, v46, v56
    v_mul_f32 v47, v47, v56
    v_exp_f32 v48, v48
    v_exp_f32 v50, v50
    v_exp_f32 v52, v52
    v_exp_f32 v54, v54
    v_exp_f32 v44, v44
    v_exp_f32 v45, v45
    v_exp_f32 v46, v46
    v_exp_f32 v47, v47
    v_mul_f32 v48, v48, v49
    v_fmac_f32 v48, v50, v51
    v_fmac_f32 v48, v52, v53
    v_fmac_f32 v48, v54, v55
    v_rcp_f32 v48, v48
    s_nop 0
    v_mul_f32 v44, v44, v48
    v_mul_f32 v45, v45, v48
    v_mul_f32 v46, v46, v48
    v_mul_f32 v47, v47, v48
    v_cvt_pk_bf16_f32 v44, v44, v45
    v_cvt_pk_bf16_f32 v46, v46, v47
    s_nop 0
    v_mov_b32_dpp v45, v44 row_half_mirror row_mask:0xf bank_mask:0xf
    v_mov_b32_dpp v47, v46 row_half_mirror row_mask:0xf bank_mask:0xf
    s_waitcnt vmcnt(11)
    buffer_load_dwordx4 v[156:159], v2, s[36:39], s78 offen offset:768 nt
    v_and_b32_dpp v12, v44, v8 quad_perm:[0,0,0,0] row_mask:0xf bank_mask:0xf
    v_and_b32_dpp v13, v45, v9 quad_perm:[3,3,3,3] row_mask:0xf bank_mask:0xf
    v_and_b32_dpp v14, v44, v10 quad_perm:[0,0,0,0] row_mask:0xf bank_mask:0xf
    v_and_b32_dpp v15, v45, v11 quad_perm:[3,3,3,3] row_mask:0xf bank_mask:0xf
    s_nop 1
    v_smfmac_f32_16x16x64_bf16 v[20:23], v[12:15], v[224:231], v7
    s_waitcnt vmcnt(11)
    s_cmp_lg_u32 s85, 2
    s_cbranch_scc1 L_skip10
    s_call_b64 s[100:101], L_burst_wo
L_skip10:
    buffer_load_dwordx4 v[144:147], v2, s[36:39], s78 offen offset:128 nt
    s_waitcnt vmcnt(11)
    buffer_load_dwordx4 v[148:151], v2, s[36:39], s78 offen offset:896 nt
    v_smfmac_f32_16x16x64_bf16 v[24:27], v[12:15], v[216:223], v7
    s_waitcnt vmcnt(11)
    buffer_load_dwordx4 v[136:139], v2, s[36:39], s78 offen offset:256 nt
    s_waitcnt vmcnt(11)
    buffer_load_dwordx4 v[140:143], v2, s[36:39], s78 offen offset:1024 nt
    s_add_u32 s71, s97, 16
    s_and_b32 s71, s71, 63
    s_lshl1_add_u32 s71, s71, 0
    s_mul_i32 s78, s71, 1536
    s_mov_b32 s68, 66048
    s_cmp_ge_u32 s71, 43
    s_cselect_b32 s70, 66048, 0
    s_add_u32 s78, s78, s70
    s_cmp_ge_u32 s71, 86
    s_cselect_b32 s68, 64512, s68
    s_cselect_b32 s70, 66048, 0
    s_add_u32 s78, s78, s70
    s_add_u32 s71, s97, 16
    s_and_b32 s71, s71, 63
    s_lshl1_add_u32 s71, s71, 1
    s_mul_i32 s69, s71, 1536
    s_cmp_ge_u32 s71, 43
    s_cselect_b32 s70, 66048, 0
    s_add_u32 s69, s69, s70
    s_cmp_ge_u32 s71, 86
    s_cselect_b32 s70, 66048, 0
    s_add_u32 s69, s69, s70
    s_sub_u32 s69, s69, s78
    s_sub_u32 s70, s68, s80
    s_mov_b32 s80, s68
    s_mov_b32 exec_lo, 0xff00ff00
    s_mov_b32 exec_hi, 0xff00ff00
    v_add_u32 v2, s70, v2
    s_mov_b64 exec, -1
    s_sub_u32 s70, s69, s82
    s_mov_b32 s82, s69
    s_mov_b32 exec_lo, 0xffff0000
    s_mov_b32 exec_hi, 0xffff0000
    v_add_u32 v2, s70, v2
    s_mov_b64 exec, -1
    v_smfmac_f32_16x16x64_bf16 v[28:31], v[12:15], v[200:207], v7
    s_waitcnt vmcnt(11)
    buffer_load_dwordx4 v[128:131], v1, s[36:39], s79 offen offset:0 nt
    s_waitcnt vmcnt(11)
    buffer_load_dwordx4 v[132:135], v1, s[36:39], s79 offen offset:768 nt
    v_and_b32_dpp v16, v44, v8 quad_perm:[1,1,1,1] row_mask:0xf bank_mask:0xf
    v_and_b32_dpp v17, v45, v9 quad_perm:[2,2,2,2] row_mask:0xf bank_mask:0xf
    v_and_b32_dpp v18, v44, v10 quad_perm:[1,1,1,1] row_mask:0xf bank_mask:0xf
    v_and_b32_dpp v19, v45, v11 quad_perm:[2,2,2,2] row_mask:0xf bank_mask:0xf
    s_nop 1
    v_smfmac_f32_16x16x64_bf16 v[20:23], v[16:19], v[192:199], v7
    s_waitcnt vmcnt(11)
    buffer_load_dwordx4 v[120:123], v1, s[36:39], s79 offen offset:128 nt
    s_waitcnt vmcnt(11)
    buffer_load_dwordx4 v[124:127], v1, s[36:39], s79 offen offset:896 nt
    v_smfmac_f32_16x16x64_bf16 v[24:27], v[16:19], v[176:183], v7
    s_waitcnt vmcnt(11)
    s_cmp_lg_u32 s85, 3
    s_cbranch_scc1 L_skip11
    s_call_b64 s[100:101], L_burst_wo
L_skip11:
    buffer_load_dwordx4 v[112:115], v1, s[36:39], s79 offen offset:256 nt
    s_waitcnt vmcnt(11)
    buffer_load_dwordx4 v[116:119], v1, s[36:39], s79 offen offset:1024 nt
    s_add_u32 s71, s97, 20
    s_and_b32 s71, s71, 63
    s_lshl1_add_u32 s71, s71, 0
    s_mul_i32 s79, s71, 1536
    s_mov_b32 s68, 66048
    s_cmp_ge_u32 s71, 43
    s_cselect_b32 s70, 66048, 0
    s_add_u32 s79, s79, s70
    s_cmp_ge_u32 s71, 86
    s_cselect_b32 s68, 64512, s68
    s_cselect_b32 s70, 66048, 0
    s_add_u32 s79, s79, s70
    s_add_u32 s71, s97, 20
    s_and_b32 s71, s71, 63
    s_lshl1_add_u32 s71, s71, 1
    s_mul_i32 s69, s71, 1536
    s_cmp_ge_u32 s71, 43
    s_cselect_b32 s70, 66048, 0
    s_add_u32 s69, s69, s70
    s_cmp_ge_u32 s71, 86
    s_cselect_b32 s70, 66048, 0
    s_add_u32 s69, s69, s70
    s_sub_u32 s69, s69, s79
    s_sub_u32 s70, s68, s81
    s_mov_b32 s81, s68
    s_mov_b32 exec_lo, 0xff00ff00
    s_mov_b32 exec_hi, 0xff00ff00
    v_add_u32 v1, s70, v1
    s_mov_b64 exec, -1
    s_sub_u32 s70, s69, s83
    s_mov_b32 s83, s69
    s_mov_b32 exec_lo, 0xffff0000
    s_mov_b32 exec_hi, 0xffff0000
    v_add_u32 v1, s70, v1
    s_mov_b64 exec, -1
    v_smfmac_f32_16x16x64_bf16 v[28:31], v[16:19], v[160:167], v7
    s_waitcnt vmcnt(11)
    buffer_load_dwordx4 v[104:107], v2, s[36:39], s78 offen offset:0 nt
    s_waitcnt vmcnt(11)
    buffer_load_dwordx4 v[108:111], v2, s[36:39], s78 offen offset:768 nt
    v_and_b32_dpp v12, v44, v8 quad_perm:[2,2,2,2] row_mask:0xf bank_mask:0xf
    v_and_b32_dpp v13, v45, v9 quad_perm:[1,1,1,1] row_mask:0xf bank_mask:0xf
    v_and_b32_dpp v14, v44, v10 quad_perm:[2,2,2,2] row_mask:0xf bank_mask:0xf
    v_and_b32_dpp v15, v45, v11 quad_perm:[1,1,1,1] row_mask:0xf bank_mask:0xf
    s_nop 1
    v_smfmac_f32_16x16x64_bf16 v[20:23], v[12:15], v[152:159], v7
    s_waitcnt vmcnt(11)
    buffer_load_dwordx2 v[56:57], off, s[60:63], 0 sc1
    s_waitcnt vmcnt(11)
    buffer_load_dwordx4 v[96:99], v2, s[36:39], s78 offen offset:128 nt
    v_smfmac_f32_16x16x64_bf16 v[24:27], v[12:15], v[144:151], v7
    s_waitcnt vmcnt(11)
    buffer_load_dwordx4 v[100:103], v2, s[36:39], s78 offen offset:896 nt
    s_waitcnt vmcnt(11)
    buffer_load_dwordx4 v[88:91], v2, s[36:39], s78 offen offset:256 nt
    v_smfmac_f32_16x16x64_bf16 v[28:31], v[12:15], v[136:143], v7
    s_waitcnt vmcnt(11)
    buffer_load_dwordx4 v[92:95], v2, s[36:39], s78 offen offset:1024 nt
    s_add_u32 s71, s97, 24
    s_and_b32 s71, s71, 63
    s_lshl1_add_u32 s71, s71, 0
    s_mul_i32 s78, s71, 1536
    s_mov_b32 s68, 66048
    s_cmp_ge_u32 s71, 43
    s_cselect_b32 s70, 66048, 0
    s_add_u32 s78, s78, s70
    s_cmp_ge_u32 s71, 86
    s_cselect_b32 s68, 64512, s68
    s_cselect_b32 s70, 66048, 0
    s_add_u32 s78, s78, s70
    s_add_u32 s71, s97, 24
    s_and_b32 s71, s71, 63
    s_lshl1_add_u32 s71, s71, 1
    s_mul_i32 s69, s71, 1536
    s_cmp_ge_u32 s71, 43
    s_cselect_b32 s70, 66048, 0
    s_add_u32 s69, s69, s70
    s_cmp_ge_u32 s71, 86
    s_cselect_b32 s70, 66048, 0
    s_add_u32 s69, s69, s70
    s_sub_u32 s69, s69, s78
    s_sub_u32 s70, s68, s80
    s_mov_b32 s80, s68
    s_mov_b32 exec_lo, 0xff00ff00
    s_mov_b32 exec_hi, 0xff00ff00
    v_add_u32 v2, s70, v2
    s_mov_b64 exec, -1
    s_sub_u32 s70, s69, s82
    s_mov_b32 s82, s69
    s_mov_b32 exec_lo, 0xffff0000
    s_mov_b32 exec_hi, 0xffff0000
    v_add_u32 v2, s70, v2
    s_mov_b64 exec, -1
    s_waitcnt vmcnt(11)
    s_cmp_lg_u32 s85, 4
    s_cbranch_scc1 L_skip12
    s_call_b64 s[100:101], L_burst_wo
L_skip12:
    buffer_load_dwordx4 v[80:83], v1, s[36:39], s79 offen offset:0 nt
    v_and_b32_dpp v16, v44, v8 quad_perm:[3,3,3,3] row_mask:0xf bank_mask:0xf
    v_and_b32_dpp v17, v45, v9 quad_perm:[0,0,0,0] row_mask:0xf bank_mask:0xf
    v_and_b32_dpp v18, v44, v10 quad_perm:[3,3,3,3] row_mask:0xf bank_mask:0xf
    v_and_b32_dpp v19, v45, v11 quad_perm:[0,0,0,0] row_mask:0xf bank_mask:0xf
    s_nop 1
    v_smfmac_f32_16x16x64_bf16 v[20:23], v[16:19], v[128:135], v7
    s_waitcnt vmcnt(11)
    buffer_load_dwordx4 v[84:87], v1, s[36:39], s79 offen offset:768 nt
    s_waitcnt vmcnt(11)
    buffer_load_dwordx4 v[72:75], v1, s[36:39], s79 offen offset:128 nt
    v_smfmac_f32_16x16x64_bf16 v[24:27], v[16:19], v[120:127], v7
    s_waitcnt vmcnt(11)
    buffer_load_dwordx4 v[76:79], v1, s[36:39], s79 offen offset:896 nt
    s_waitcnt vmcnt(11)
    buffer_load_dwordx4 v[64:67], v1, s[36:39], s79 offen offset:256 nt
    v_smfmac_f32_16x16x64_bf16 v[28:31], v[16:19], v[112:119], v7
    s_waitcnt vmcnt(11)
    buffer_load_dwordx4 v[68:71], v1, s[36:39], s79 offen offset:1024 nt
    s_add_u32 s71, s97, 28
    s_and_b32 s71, s71, 63
    s_lshl1_add_u32 s71, s71, 0
    s_mul_i32 s79, s71, 1536
    s_mov_b32 s68, 66048
    s_cmp_ge_u32 s71, 43
    s_cselect_b32 s70, 66048, 0
    s_add_u32 s79, s79, s70
    s_cmp_ge_u32 s71, 86
    s_cselect_b32 s68, 64512, s68
    s_cselect_b32 s70, 66048, 0
    s_add_u32 s79, s79, s70
    s_add_u32 s71, s97, 28
    s_and_b32 s71, s71, 63
    s_lshl1_add_u32 s71, s71, 1
    s_mul_i32 s69, s71, 1536
    s_cmp_ge_u32 s71, 43
    s_cselect_b32 s70, 66048, 0
    s_add_u32 s69, s69, s70
    s_cmp_ge_u32 s71, 86
    s_cselect_b32 s70, 66048, 0
    s_add_u32 s69, s69, s70
    s_sub_u32 s69, s69, s79
    s_sub_u32 s70, s68, s81
    s_mov_b32 s81, s68
    s_mov_b32 exec_lo, 0xff00ff00
    s_mov_b32 exec_hi, 0xff00ff00
    v_add_u32 v1, s70, v1
    s_mov_b64 exec, -1
    s_sub_u32 s70, s69, s83
    s_mov_b32 s83, s69
    s_mov_b32 exec_lo, 0xffff0000
    s_mov_b32 exec_hi, 0xffff0000
    v_add_u32 v1, s70, v1
    s_mov_b64 exec, -1
    s_waitcnt vmcnt(11)
    buffer_load_dwordx4 v[248:251], v2, s[36:39], s78 offen offset:0 nt
    v_and_b32_dpp v12, v45, v8 quad_perm:[3,3,3,3] row_mask:0xf bank_mask:0xf
    v_and_b32_dpp v13, v44, v9 quad_perm:[0,0,0,0] row_mask:0xf bank_mask:0xf
    v_and_b32_dpp v14, v45, v10 quad_perm:[3,3,3,3] row_mask:0xf bank_mask:0xf
    v_and_b32_dpp v15, v44, v11 quad_perm:[0,0,0,0] row_mask:0xf bank_mask:0xf
    s_nop 1
    v_smfmac_f32_16x16x64_bf16 v[20:23], v[12:15], v[104:111], v7
    s_waitcnt vmcnt(11)
    buffer_load_dwordx4 v[252:255], v2, s[36:39], s78 offen offset:768 nt
    s_waitcnt vmcnt(11)
    s_cmp_lg_u32 s85, 5
    s_cbranch_scc1 L_skip13
    s_call_b64 s[100:101], L_burst_wo
L_skip13:
    buffer_load_dwordx4 v[232:235], v2, s[36:39], s78 offen offset:128 nt
    s_waitcnt vmcnt(11)
    buffer_load_dwordx4 v[236:239], v2, s[36:39], s78 offen offset:896 nt
    v_smfmac_f32_16x16x64_bf16 v[24:27], v[12:15], v[96:103], v7
    s_waitcnt vmcnt(11)
    buffer_load_dwordx4 v[168:171], v2, s[36:39], s78 offen offset:256 nt
    s_waitcnt vmcnt(11)
    buffer_load_dwordx4 v[172:175], v2, s[36:39], s78 offen offset:1024 nt
    s_add_u32 s71, s97, 32
    s_and_b32 s71, s71, 63
    s_lshl1_add_u32 s71, s71, 0
    s_mul_i32 s78, s71, 1536
    s_mov_b32 s68, 66048
    s_cmp_ge_u32 s71, 43
    s_cselect_b32 s70, 66048, 0
    s_add_u32 s78, s78, s70
    s_cmp_ge_u32 s71, 86
    s_cselect_b32 s68, 64512, s68
    s_cselect_b32 s70, 66048, 0
    s_add_u32 s78, s78, s70
    s_add_u32 s71, s97, 32
    s_and_b32 s71, s71, 63
    s_lshl1_add_u32 s71, s71, 1
    s_mul_i32 s69, s71, 1536
    s_cmp_ge_u32 s71, 43
    s_cselect_b32 s70, 66048, 0
    s_add_u32 s69, s69, s70
    s_cmp_ge_u32 s71, 86
    s_cselect_b32 s70, 66048, 0
    s_add_u32 s69, s69, s70
    s_sub_u32 s69, s69, s78
    s_sub_u32 s70, s68, s80
    s_mov_b32 s80, s68
    s_mov_b32 exec_lo, 0xff00ff00
    s_mov_b32 exec_hi, 0xff00ff00
    v_add_u32 v2, s70, v2
    s_mov_b64 exec, -1
    s_sub_u32 s70, s69, s82
    s_mov_b32 s82, s69
    s_mov_b32 exec_lo, 0xffff0000
    s_mov_b32 exec_hi, 0xffff0000
    v_add_u32 v2, s70, v2
    s_mov_b64 exec, -1
    v_smfmac_f32_16x16x64_bf16 v[28:31], v[12:15], v[88:95], v7
    s_waitcnt vmcnt(11)
    buffer_load_dwordx4 v[184:187], v1, s[36:39], s79 offen offset:0 nt
    s_mov_b32 s98, 0
    v_cmp_eq_u32 vcc, 0, v56
    s_cbranch_vccnz L_cntwait
L_cntok:
    v_readfirstlane_b32 s72, v57
    v_mov_b32 v35, v56
    s_and_b32 s73, s72, 2
    s_lshr_b32 s72, s72, 4
    s_waitcnt vmcnt(11)
    s_lshr_b32 s91, s2, 3
    s_lshl_b32 s91, s91, 2
    s_add_u32 s91, s91, s3
    s_mul_i32 s91, s91, 15360
    v_mul_u32_u24 v59, 21846, v0
    v_lshrrev_b32 v59, 16, v59
    v_mul_u32_u24 v59, 2688, v59
    v_lshl_add_u32 v59, v0, 7, v59
    s_mov_b32 exec_lo, 0x7
    s_mov_b32 exec_hi, 0x0
    buffer_load_dword v60, v59, s[48:51], s91 offen
    s_mov_b64 exec, -1
    buffer_load_dwordx4 v[188:191], v1, s[36:39], s79 offen offset:768 nt
    v_and_b32_dpp v16, v45, v8 quad_perm:[2,2,2,2] row_mask:0xf bank_mask:0xf
    v_and_b32_dpp v17, v44, v9 quad_perm:[1,1,1,1] row_mask:0xf bank_mask:0xf
    v_and_b32_dpp v18, v45, v10 quad_perm:[2,2,2,2] row_mask:0xf bank_mask:0xf
    v_and_b32_dpp v19, v44, v11 quad_perm:[1,1,1,1] row_mask:0xf bank_mask:0xf
    s_nop 1
    v_smfmac_f32_16x16x64_bf16 v[20:23], v[16:19], v[80:87], v7
    s_waitcnt vmcnt(11)
    buffer_load_dwordx4 v[208:211], v1, s[36:39], s79 offen offset:128 nt
    s_waitcnt vmcnt(11)
    buffer_load_dwordx4 v[212:215], v1, s[36:39], s79 offen offset:896 nt
    v_smfmac_f32_16x16x64_bf16 v[24:27], v[16:19], v[72:79], v7
    s_waitcnt vmcnt(11)
    s_cmp_lg_u32 s85, 6
    s_cbranch_scc1 L_skip14
    s_call_b64 s[100:101], L_burst_wo
L_skip14:
    s_lshr_b32 s91, s2, 3
    s_lshl_b32 s91, s91, 2
    s_add_u32 s91, s91, s3
    s_mul_i32 s91, s91, 15360
    v_mul_u32_u24 v59, 21846, v0
    v_lshrrev_b32 v59, 16, v59
    v_mul_u32_u24 v59, 2688, v59
    v_lshl_add_u32 v59, v0, 7, v59
    s_mov_b32 exec_lo, 0x78
    s_mov_b32 exec_hi, 0x0
    buffer_load_dword v60, v59, s[48:51], s91 offen
    s_mov_b64 exec, -1
    buffer_load_dwordx4 v[240:243], v1, s[36:39], s79 offen offset:256 nt
    s_waitcnt vmcnt(11)
    buffer_load_dwordx4 v[244:247], v1, s[36:39], s79 offen offset:1024 nt
    s_add_u32 s71, s97, 36
    s_and_b32 s71, s71, 63
    s_lshl1_add_u32 s71, s71, 0
    s_mul_i32 s79, s71, 1536
    s_mov_b32 s68, 66048
    s_cmp_ge_u32 s71, 43
    s_cselect_b32 s70, 66048, 0
    s_add_u32 s79, s79, s70
    s_cmp_ge_u32 s71, 86
    s_cselect_b32 s68, 64512, s68
    s_cselect_b32 s70, 66048, 0
    s_add_u32 s79, s79, s70
    s_add_u32 s71, s97, 36
    s_and_b32 s71, s71, 63
    s_lshl1_add_u32 s71, s71, 1
    s_mul_i32 s69, s71, 1536
    s_cmp_ge_u32 s71, 43
    s_cselect_b32 s70, 66048, 0
    s_add_u32 s69, s69, s70
    s_cmp_ge_u32 s71, 86
    s_cselect_b32 s70, 66048, 0
    s_add_u32 s69, s69, s70
    s_sub_u32 s69, s69, s79
    s_sub_u32 s70, s68, s81
    s_mov_b32 s81, s68
    s_mov_b32 exec_lo, 0xff00ff00
    s_mov_b32 exec_hi, 0xff00ff00
    v_add_u32 v1, s70, v1
    s_mov_b64 exec, -1
    s_sub_u32 s70, s69, s83
    s_mov_b32 s83, s69
    s_mov_b32 exec_lo, 0xffff0000
    s_mov_b32 exec_hi, 0xffff0000
    v_add_u32 v1, s70, v1
    s_mov_b64 exec, -1
    v_smfmac_f32_16x16x64_bf16 v[28:31], v[16:19], v[64:71], v7
    s_waitcnt vmcnt(11)
    buffer_load_dwordx4 v[224:227], v2, s[36:39], s78 offen offset:0 nt
    v_and_b32 v48, 7, v0
    v_lshrrev_b32 v49, 3, v0
    v_and_b32 v50, 15, v0
    v_bfe_u32 v51, v0, 4, 1
    v_bfe_u32 v52, v0, 3, 1
    v_lshrrev_b32 v53, 5, v0
    v_mov_b32 v55, 1073741824
    v_min_u32 v54, 1, v50
    v_lshlrev_b32 v54, 7, v54
    v_lshrrev_b32 v32, 4, v0
    v_lshl_add_u32 v32, v32, 5, v54
    s_mul_i32 s94, s3, 256
    v_add_u32 v32, s94, v32
    v_lshlrev_b32 v54, 9, v53
    v_lshl_add_u32 v54, v50, 5, v54
    v_lshl_add_u32 v54, v51, 4, v54
    s_mul_i32 s94, s3, 3072
    v_add_u32 v33, s94, v54
    s_mul_i32 s94, s3, 5
    v_add_u32 v54, s94, v49
    v_lshrrev_b32 v34, 1, v54
    v_lshlrev_b32 v34, 8, v34
    v_and_b32 v54, 1, v54
    v_lshl_add_u32 v34, v54, 4, v34
    v_lshl_add_u32 v34, v48, 5, v34
    s_mul_i32 s94, s26, 98304
    s_lshl_b32 s95, s27, 7
    s_add_u32 s94, s94, s95
    s_mul_i32 s95, s3, 5
    v_add_u32 v62, s95, v49
    v_add_u32 v54, s72, v62
    v_bfi_b32 v62, 7, v54, v62
    v_bfe_u32 v54, v62, 1, 2
    v_mul_u32_u24 v54, 5, v54
    v_bfi_b32 v62, 6, v54, v62
    v_xor_b32 v62, s73, v62
    v_lshl_add_u32 v62, v62, 12, s94
    v_lshl_add_u32 v62, v48, 4, v62
    v_cmp_gt_u32 vcc, 40, v0
    s_sub_u32 s95, s27, 16
    s_cmp_lt_u32 s27, 20
    s_cselect_b32 s95, s27, s95
    v_cndmask_b32 v62, v55, v62, vcc
    s_add_u32 s94, s95, s72
    s_and_b32 s94, s94, 7
    s_and_b32 s95, s95, 0x38
    s_or_b32 s95, s95, s94
    s_bfe_u32 s94, s95, 0x20001
    s_mul_i32 s94, s94, 5
    s_and_b32 s94, s94, 6
    s_and_b32 s95, s95, 0x39
    s_or_b32 s95, s95, s94
    s_xor_b32 s95, s95, s73
    s_lshl_b32 s95, s95, 12
    s_mul_i32 s94, s26, 98304
    s_add_u32 s94, s94, s95
    v_lshl_add_u32 v36, v0, 4, s94
    s_and_b32 s95, s27, 7
    s_add_u32 s94, s95, s72
    s_and_b32 s94, s94, 7
    s_and_b32 s95, s95, 0x38
    s_or_b32 s95, s95, s94
    s_bfe_u32 s94, s95, 0x20001
    s_mul_i32 s94, s94, 5
    s_and_b32 s94, s94, 6
    s_and_b32 s95, s95, 0x39
    s_or_b32 s95, s95, s94
    s_xor_b32 s95, s95, s73
    s_lshl_b32 s95, s95, 12
    s_lshl_b32 s94, s26, 15
    s_add_u32 s94, s94, s95
    s_add_u32 s94, s94, 1572864
    v_lshl_add_u32 v38, v0, 3, s94
    s_lshl_b32 s95, s3, 1
    v_xor_b32 v54, s95, v0
    v_lshl_add_u32 v39, v54, 3, s94
    s_add_u32 s32, s3, 0
    s_and_b32 s32, s32, 3
    s_lshl_b32 s32, s32, 9
    s_mov_b32 s40, 0
    s_add_u32 s33, s3, 1
    s_and_b32 s33, s33, 3
    s_lshl_b32 s33, s33, 9
    s_mov_b32 s41, 1024
    s_add_u32 s34, s3, 2
    s_and_b32 s34, s34, 3
    s_lshl_b32 s34, s34, 9
    s_mov_b32 s42, 2048
    s_add_u32 s35, s3, 3
    s_and_b32 s35, s35, 3
    s_lshl_b32 s35, s35, 9
    s_mov_b32 s43, 3072
    v_and_b32 v54, 3, v48
    v_min_u32 v54, 2, v54
    v_lshlrev_b32 v54, 8, v54
    v_lshl_add_u32 v40, v49, 5, v54
    s_mul_i32 s94, s26, 98304
    s_lshl_b32 s95, s27, 7
    s_add_u32 s94, s94, s95
    s_add_u32 s94, s94, 786432
    s_lshl_b32 s95, s3, 1
    v_add_u32 v41, s95, v53
    s_add_u32 s95, s3, 8
    v_mov_b32 v50, s95
    v_cmp_eq_u32 vcc, 1, v52
    s_nop 1
    v_cndmask_b32 v41, v41, v50, vcc
    v_lshl_add_u32 v41, v41, 1, v51
    v_add_u32 v54, s72, v41
    v_bfi_b32 v41, 7, v54, v41
    v_bfe_u32 v54, v41, 1, 2
    v_mul_u32_u24 v54, 5, v54
    v_bfi_b32 v41, 6, v54, v41
    v_xor_b32 v41, s73, v41
    v_lshl_add_u32 v41, v41, 12, s94
    v_lshl_add_u32 v41, v48, 4, v41
    s_cmp_lt_u32 s3, 2
    s_cselect_b32 vcc_hi, -1, 0x00ff00ff
    s_mov_b32 vcc_lo, 0x00ff00ff
    v_cndmask_b32 v41, v55, v41, vcc
    s_lshr_b32 s94, s27, 1
    s_lshl_b32 s94, s94, 7
    s_and_b32 s95, s27, 1
    s_lshl_b32 s95, s95, 3
    s_add_u32 s94, s94, s95
    v_and_b32 v49, 3, v49
    v_lshl_add_u32 v54, v48, 3, v49
    v_lshl_add_u32 v43, v54, 1, s94
    v_cmp_gt_u32 vcc, 32, v0
    s_nop 1
    v_cndmask_b32 v42, v55, v43, vcc
    s_waitcnt vmcnt(11)
    s_lshr_b32 s91, s2, 3
    s_lshl_b32 s91, s91, 2
    s_add_u32 s91, s91, s3
    s_mul_i32 s91, s91, 15360
    v_mul_u32_u24 v59, 21846, v0
    v_lshrrev_b32 v59, 16, v59
    v_mul_u32_u24 v59, 2688, v59
    v_lshl_add_u32 v59, v0, 7, v59
    s_mov_b32 exec_lo, 0x780
    s_mov_b32 exec_hi, 0x0
    buffer_load_dword v60, v59, s[48:51], s91 offen
    s_mov_b64 exec, -1
    buffer_load_dwordx4 v[228:231], v2, s[36:39], s78 offen offset:768 nt
    v_and_b32_dpp v12, v45, v8 quad_perm:[1,1,1,1] row_mask:0xf bank_mask:0xf
    v_and_b32_dpp v13, v44, v9 quad_perm:[2,2,2,2] row_mask:0xf bank_mask:0xf
    v_and_b32_dpp v14, v45, v10 quad_perm:[1,1,1,1] row_mask:0xf bank_mask:0xf
    v_and_b32_dpp v15, v44, v11 quad_perm:[2,2,2,2] row_mask:0xf bank_mask:0xf
    s_nop 1
    v_smfmac_f32_16x16x64_bf16 v[20:23], v[12:15], v[248:255], v7
    s_waitcnt vmcnt(11)
    buffer_load_dwordx4 v[216:219], v2, s[36:39], s78 offen offset:128 nt
    s_waitcnt vmcnt(11)
    buffer_load_dwordx4 v[220:223], v2, s[36:39], s78 offen offset:896 nt
    v_smfmac_f32_16x16x64_bf16 v[24:27], v[12:15], v[232:239], v7
    s_waitcnt vmcnt(11)
    s_lshr_b32 s91, s2, 3
    s_lshl_b32 s91, s91, 2
    s_add_u32 s91, s91, s3
    s_mul_i32 s91, s91, 15360
    v_mul_u32_u24 v59, 21846, v0
    v_lshrrev_b32 v59, 16, v59
    v_mul_u32_u24 v59, 2688, v59
    v_lshl_add_u32 v59, v0, 7, v59
    s_mov_b32 exec_lo, 0x7800
    s_mov_b32 exec_hi, 0x0
    buffer_load_dword v60, v59, s[48:51], s91 offen
    s_mov_b64 exec, -1
    buffer_load_dwordx4 v[200:203], v2, s[36:39], s78 offen offset:256 nt
    s_waitcnt vmcnt(11)
    buffer_load_dwordx4 v[204:207], v2, s[36:39], s78 offen offset:1024 nt
    s_add_u32 s71, s97, 40
    s_and_b32 s71, s71, 63
    s_lshl1_add_u32 s71, s71, 0
    s_mul_i32 s78, s71, 1536
    s_mov_b32 s68, 66048
    s_cmp_ge_u32 s71, 43
    s_cselect_b32 s70, 66048, 0
    s_add_u32 s78, s78, s70
    s_cmp_ge_u32 s71, 86
    s_cselect_b32 s68, 64512, s68
    s_cselect_b32 s70, 66048, 0
    s_add_u32 s78, s78, s70
    s_add_u32 s71, s97, 40
    s_and_b32 s71, s71, 63
    s_lshl1_add_u32 s71, s71, 1
    s_mul_i32 s69, s71, 1536
    s_cmp_ge_u32 s71, 43
    s_cselect_b32 s70, 66048, 0
    s_add_u32 s69, s69, s70
    s_cmp_ge_u32 s71, 86
    s_cselect_b32 s70, 66048, 0
    s_add_u32 s69, s69, s70
    s_sub_u32 s69, s69, s78
    s_sub_u32 s70, s68, s80
    s_mov_b32 s80, s68
    s_mov_b32 exec_lo, 0xff00ff00
    s_mov_b32 exec_hi, 0xff00ff00
    v_add_u32 v2, s70, v2
    s_mov_b64 exec, -1
    s_sub_u32 s70, s69, s82
    s_mov_b32 s82, s69
    s_mov_b32 exec_lo, 0xffff0000
    s_mov_b32 exec_hi, 0xffff0000
    v_add_u32 v2, s70, v2
    s_mov_b64 exec, -1
    v_smfmac_f32_16x16x64_bf16 v[28:31], v[12:15], v[168:175], v7
    s_waitcnt vmcnt(11)
    s_cmp_lg_u32 s85, 7
    s_cbranch_scc1 L_skip15
    s_call_b64 s[100:101], L_burst_wo
L_skip15:
    buffer_load_dwordx4 v[192:195], v1, s[36:39], s79 offen offset:0 nt
    s_waitcnt vmcnt(11)
    buffer_load_dwordx4 v[196:199], v1, s[36:39], s79 offen offset:768 nt
    v_and_b32_dpp v16, v45, v8 quad_perm:[0,0,0,0] row_mask:0xf bank_mask:0xf
    v_and_b32_dpp v17, v44, v9 quad_perm:[3,3,3,3] row_mask:0xf bank_mask:0xf
    v_and_b32_dpp v18, v45, v10 quad_perm:[0,0,0,0] row_mask:0xf bank_mask:0xf
    v_and_b32_dpp v19, v44, v11 quad_perm:[3,3,3,3] row_mask:0xf bank_mask:0xf
    s_nop 1
    v_smfmac_f32_16x16x64_bf16 v[20:23], v[16:19], v[184:191], v7
    s_waitcnt vmcnt(11)
    buffer_load_dwordx4 v[176:179], v1, s[36:39], s79 offen offset:128 nt
    s_waitcnt vmcnt(11)
    buffer_load_dwordx4 v[180:183], v1, s[36:39], s79 offen offset:896 nt
    v_smfmac_f32_16x16x64_bf16 v[24:27], v[16:19], v[208:215], v7
    s_waitcnt vmcnt(11)
    buffer_load_dwordx4 v[160:163], v1, s[36:39], s79 offen offset:256 nt
    s_waitcnt vmcnt(11)
    buffer_load_dwordx4 v[164:167], v1, s[36:39], s79 offen offset:1024 nt
    s_add_u32 s71, s97, 44
    s_and_b32 s71, s71, 63
    s_lshl1_add_u32 s71, s71, 0
    s_mul_i32 s79, s71, 1536
    s_mov_b32 s68, 66048
    s_cmp_ge_u32 s71, 43
    s_cselect_b32 s70, 66048, 0
    s_add_u32 s79, s79, s70
    s_cmp_ge_u32 s71, 86
    s_cselect_b32 s68, 64512, s68
    s_cselect_b32 s70, 66048, 0
    s_add_u32 s79, s79, s70
    s_add_u32 s71, s97, 44
    s_and_b32 s71, s71, 63
    s_lshl1_add_u32 s71, s71, 1
    s_mul_i32 s69, s71, 1536
    s_cmp_ge_u32 s71, 43
    s_cselect_b32 s70, 66048, 0
    s_add_u32 s69, s69, s70
    s_cmp_ge_u32 s71, 86
    s_cselect_b32 s70, 66048, 0
    s_add_u32 s69, s69, s70
    s_sub_u32 s69, s69, s79
    s_sub_u32 s70, s68, s81
    s_mov_b32 s81, s68
    s_mov_b32 exec_lo, 0xff00ff00
    s_mov_b32 exec_hi, 0xff00ff00
    v_add_u32 v1, s70, v1
    s_mov_b64 exec, -1
    s_sub_u32 s70, s69, s83
    s_mov_b32 s83, s69
    s_mov_b32 exec_lo, 0xffff0000
    s_mov_b32 exec_hi, 0xffff0000
    v_add_u32 v1, s70, v1
    s_mov_b64 exec, -1
    v_smfmac_f32_16x16x64_bf16 v[28:31], v[16:19], v[240:247], v7
    s_waitcnt vmcnt(11)
    buffer_load_ushort v43, v43, s[28:31], 0 offen
    s_waitcnt vmcnt(11)
    buffer_load_dwordx4 v[152:155], v2, s[36:39], s78 offen offset:0 nt
    v_and_b32_dpp v12, v46, v8 quad_perm:[0,0,0,0] row_mask:0xf bank_mask:0xf
    v_and_b32_dpp v13, v47, v9 quad_perm:[3,3,3,3] row_mask:0xf bank_mask:0xf
    v_and_b32_dpp v14, v46, v10 quad_perm:[0,0,0,0] row_mask:0xf bank_mask:0xf
    v_and_b32_dpp v15, v47, v11 quad_perm:[3,3,3,3] row_mask:0xf bank_mask:0xf
    s_nop 1
    v_smfmac_f32_16x16x64_bf16 v[20:23], v[12:15], v[224:231], v7
    s_waitcnt vmcnt(11)
    buffer_load_dwordx4 v[156:159], v2, s[36:39], s78 offen offset:768 nt
    s_waitcnt vmcnt(11)
    buffer_load_dwordx4 v[144:147], v2, s[36:39], s78 offen offset:128 nt
    v_smfmac_f32_16x16x64_bf16 v[24:27], v[12:15], v[216:223], v7
    s_waitcnt vmcnt(11)
    buffer_load_dwordx4 v[148:151], v2, s[36:39], s78 offen offset:896 nt
    s_waitcnt vmcnt(11)
    buffer_load_dwordx4 v[136:139], v2, s[36:39], s78 offen offset:256 nt
    v_smfmac_f32_16x16x64_bf16 v[28:31], v[12:15], v[200:207], v7
    s_waitcnt vmcnt(11)
    buffer_load_dwordx4 v[140:143], v2, s[36:39], s78 offen offset:1024 nt
    s_add_u32 s71, s97, 48
    s_and_b32 s71, s71, 63
    s_lshl1_add_u32 s71, s71, 0
    s_mul_i32 s78, s71, 1536
    s_mov_b32 s68, 66048
    s_cmp_ge_u32 s71, 43
    s_cselect_b32 s70, 66048, 0
    s_add_u32 s78, s78, s70
    s_cmp_ge_u32 s71, 86
    s_cselect_b32 s68, 64512, s68
    s_cselect_b32 s70, 66048, 0
    s_add_u32 s78, s78, s70
    s_add_u32 s71, s97, 48
    s_and_b32 s71, s71, 63
    s_lshl1_add_u32 s71, s71, 1
    s_mul_i32 s69, s71, 1536
    s_cmp_ge_u32 s71, 43
    s_cselect_b32 s70, 66048, 0
    s_add_u32 s69, s69, s70
    s_cmp_ge_u32 s71, 86
    s_cselect_b32 s70, 66048, 0
    s_add_u32 s69, s69, s70
    s_sub_u32 s69, s69, s78
    s_sub_u32 s70, s68, s80
    s_mov_b32 s80, s68
    s_mov_b32 exec_lo, 0xff00ff00
    s_mov_b32 exec_hi, 0xff00ff00
    v_add_u32 v2, s70, v2
    s_mov_b64 exec, -1
    s_sub_u32 s70, s69, s82
    s_mov_b32 s82, s69
    s_mov_b32 exec_lo, 0xffff0000
    s_mov_b32 exec_hi, 0xffff0000
    v_add_u32 v2, s70, v2
    s_mov_b64 exec, -1
    s_waitcnt vmcnt(11)
    s_cmp_lg_u32 s85, 0
    s_cbranch_scc1 L_skip16
    s_call_b64 s[100:101], L_burst_w1
L_skip16:
    buffer_load_dwordx4 v[168:171], v1, s[36:39], s79 offen offset:0 nt
    v_and_b32_dpp v16, v46, v8 quad_perm:[1,1,1,1] row_mask:0xf bank_mask:0xf
    v_and_b32_dpp v17, v47, v9 quad_perm:[2,2,2,2] row_mask:0xf bank_mask:0xf
    v_and_b32_dpp v18, v46, v10 quad_perm:[1,1,1,1] row_mask:0xf bank_mask:0xf
    v_and_b32_dpp v19, v47, v11 quad_perm:[2,2,2,2] row_mask:0xf bank_mask:0xf
    s_nop 1
    v_smfmac_f32_16x16x64_bf16 v[20:23], v[16:19], v[192:199], v7
    s_waitcnt vmcnt(11)
    buffer_load_dwordx4 v[172:175], v1, s[36:39], s79 offen offset:768 nt
    s_waitcnt vmcnt(11)
    buffer_load_dwordx4 v[128:131], v1, s[36:39], s79 offen offset:128 nt
    v_smfmac_f32_16x16x64_bf16 v[24:27], v[16:19], v[176:183], v7
    s_waitcnt vmcnt(11)
    s_cmp_lg_u32 s85, 1
    s_cbranch_scc1 L_skip17
    s_call_b64 s[100:101], L_burst_w1
L_skip17:
    buffer_load_dwordx4 v[132:135], v1, s[36:39], s79 offen offset:896 nt
    s_waitcnt vmcnt(11)
    s_lshr_b32 s91, s2, 3
    s_or_b32 s91, s91, s3
    s_cbranch_scc1 L_nopf1
    s_getpc_b64 s[100:101]
L_pc_L_tail:
    s_add_u32 s100, s100, L_tail-L_pc_L_tail
    s_addc_u32 s101, s101, 0
    v_lshlrev_b32 v37, 7, v0
    v_min_u32 v37, L_last-L_tail, v37
    global_load_dword v37, v37, s[100:101]
L_nopf1:
    buffer_load_dwordx4 v[120:123], v1, s[36:39], s79 offen offset:256 nt
    v_smfmac_f32_16x16x64_bf16 v[28:31], v[16:19], v[160:167], v7
    s_waitcnt vmcnt(11)
    buffer_load_dwordx4 v[124:127], v1, s[36:39], s79 offen offset:1024 nt
    s_add_u32 s71, s97, 52
    s_and_b32 s71, s71, 63
    s_lshl1_add_u32 s71, s71, 0
    s_mul_i32 s79, s71, 1536
    s_mov_b32 s68, 66048
    s_cmp_ge_u32 s71, 43
    s_cselect_b32 s70, 66048, 0
    s_add_u32 s79, s79, s70
    s_cmp_ge_u32 s71, 86
    s_cselect_b32 s68, 64512, s68
    s_cselect_b32 s70, 66048, 0
    s_add_u32 s79, s79, s70
    s_add_u32 s71, s97, 52
    s_and_b32 s71, s71, 63
    s_lshl1_add_u32 s71, s71, 1
    s_mul_i32 s69, s71, 1536
    s_cmp_ge_u32 s71, 43
    s_cselect_b32 s70, 66048, 0
    s_add_u32 s69, s69, s70
    s_cmp_ge_u32 s71, 86
    s_cselect_b32 s70, 66048, 0
    s_add_u32 s69, s69, s70
    s_sub_u32 s69, s69, s79
    s_sub_u32 s70, s68, s81
    s_mov_b32 s81, s68
    s_mov_b32 exec_lo, 0xff00ff00
    s_mov_b32 exec_hi, 0xff00ff00
    v_add_u32 v1, s70, v1
    s_mov_b64 exec, -1
    s_sub_u32 s70, s69, s83
    s_mov_b32 s83, s69
    s_mov_b32 exec_lo, 0xffff0000
    s_mov_b32 exec_hi, 0xffff0000
    v_add_u32 v1, s70, v1
    s_mov_b64 exec, -1
    s_waitcnt vmcnt(11)
    s_cmp_lg_u32 s85, 2
    s_cbranch_scc1 L_skip18
    s_call_b64 s[100:101], L_burst_w1
L_skip18:
    buffer_load_dwordx4 v[112:115], v2, s[36:39], s78 offen offset:0 nt
    s_waitcnt vmcnt(11)
    buffer_load_dwordx4 v[116:119], v2, s[36:39], s78 offen offset:768 nt
    v_and_b32_dpp v12, v46, v8 quad_perm:[2,2,2,2] row_mask:0xf bank_mask:0xf
    v_and_b32_dpp v13, v47, v9 quad_perm:[1,1,1,1] row_mask:0xf bank_mask:0xf
    v_and_b32_dpp v14, v46, v10 quad_perm:[2,2,2,2] row_mask:0xf bank_mask:0xf
    v_and_b32_dpp v15, v47, v11 quad_perm:[1,1,1,1] row_mask:0xf bank_mask:0xf
    s_nop 1
    v_smfmac_f32_16x16x64_bf16 v[20:23], v[12:15], v[152:159], v7
    s_waitcnt vmcnt(11)
    buffer_load_dwordx4 v[104:107], v2, s[36:39], s78 offen offset:128 nt
    s_waitcnt vmcnt(11)
    s_cmp_lg_u32 s85, 3
    s_cbranch_scc1 L_skip19
    s_call_b64 s[100:101], L_burst_w1
L_skip19:
    buffer_load_dwordx4 v[108:111], v2, s[36:39], s78 offen offset:896 nt
    v_smfmac_f32_16x16x64_bf16 v[24:27], v[12:15], v[144:151], v7
    s_waitcnt vmcnt(11)
    buffer_load_dwordx4 v[96:99], v2, s[36:39], s78 offen offset:256 nt
    s_waitcnt vmcnt(11)
    buffer_load_dwordx4 v[100:103], v2, s[36:39], s78 offen offset:1024 nt
    s_add_u32 s71, s97, 56
    s_and_b32 s71, s71, 63
    s_lshl1_add_u32 s71, s71, 0
    s_mul_i32 s78, s71, 1536
    s_mov_b32 s68, 66048
    s_cmp_ge_u32 s71, 43
    s_cselect_b32 s70, 66048, 0
    s_add_u32 s78, s78, s70
    s_cmp_ge_u32 s71, 86
    s_cselect_b32 s68, 64512, s68
    s_cselect_b32 s70, 66048, 0
    s_add_u32 s78, s78, s70
    s_add_u32 s71, s97, 56
    s_and_b32 s71, s71, 63
    s_lshl1_add_u32 s71, s71, 1
    s_mul_i32 s69, s71, 1536
    s_cmp_ge_u32 s71, 43
    s_cselect_b32 s70, 66048, 0
    s_add_u32 s69, s69, s70
    s_cmp_ge_u32 s71, 86
    s_cselect_b32 s70, 66048, 0
    s_add_u32 s69, s69, s70
    s_sub_u32 s69, s69, s78
    s_sub_u32 s70, s68, s80
    s_mov_b32 s80, s68
    s_mov_b32 exec_lo, 0xff00ff00
    s_mov_b32 exec_hi, 0xff00ff00
    v_add_u32 v2, s70, v2
    s_mov_b64 exec, -1
    s_sub_u32 s70, s69, s82
    s_mov_b32 s82, s69
    s_mov_b32 exec_lo, 0xffff0000
    s_mov_b32 exec_hi, 0xffff0000
    v_add_u32 v2, s70, v2
    s_mov_b64 exec, -1
    v_smfmac_f32_16x16x64_bf16 v[28:31], v[12:15], v[136:143], v7
    s_waitcnt vmcnt(11)
    s_cmp_lg_u32 s85, 4
    s_cbranch_scc1 L_skip20
    s_call_b64 s[100:101], L_burst_w1
L_skip20:
    buffer_load_dwordx4 v[88:91], v1, s[36:39], s79 offen offset:0 nt
    v_readfirstlane_b32 s94, v35
    v_mov_b32 v4, 0xffffff00
    v_and_b32 v58, 3, v0
    v_lshlrev_b32 v58, 3, v58
    v_bfe_u32 v58, v35, v58, 8
    v_and_b32 v59, 1, v0
    v_cmp_eq_u32 vcc, 0, v59
    v_lshlrev_b32 v59, 4, v59
    v_bfe_u32 v59, v35, v59, 16
    v_bfe_u32 v3, v0, 1, 1
    s_mov_b32 s74, 8192
    s_mov_b32 s75, 16384
    s_mov_b32 s76, 24576
    v_lshlrev_b32 v3, 4, v3
    v_bfe_u32 v3, v35, v3, 16
    v_cndmask_b32 v3, 0, v3, vcc
    s_waitcnt vmcnt(11)
    buffer_load_dwordx4 v[92:95], v1, s[36:39], s79 offen offset:768 nt
    v_and_b32_dpp v16, v46, v8 quad_perm:[3,3,3,3] row_mask:0xf bank_mask:0xf
    v_and_b32_dpp v17, v47, v9 quad_perm:[0,0,0,0] row_mask:0xf bank_mask:0xf
    v_and_b32_dpp v18, v46, v10 quad_perm:[3,3,3,3] row_mask:0xf bank_mask:0xf
    v_and_b32_dpp v19, v47, v11 quad_perm:[0,0,0,0] row_mask:0xf bank_mask:0xf
    s_nop 1
    v_smfmac_f32_16x16x64_bf16 v[20:23], v[16:19], v[168:175], v7
    s_waitcnt vmcnt(11)
    buffer_load_dwordx4 v[80:83], v1, s[36:39], s79 offen offset:128 nt
    s_waitcnt vmcnt(11)
    s_cmp_lg_u32 s85, 5
    s_cbranch_scc1 L_skip21
    s_call_b64 s[100:101], L_burst_w1
L_skip21:
    buffer_load_dwordx4 v[84:87], v1, s[36:39], s79 offen offset:896 nt
    v_smfmac_f32_16x16x64_bf16 v[24:27], v[16:19], v[128:135], v7
    s_waitcnt vmcnt(11)
    buffer_load_dwordx4 v[72:75], v1, s[36:39], s79 offen offset:256 nt
    s_waitcnt vmcnt(11)
    buffer_load_dwordx4 v[76:79], v1, s[36:39], s79 offen offset:1024 nt
    s_add_u32 s71, s97, 60
    s_and_b32 s71, s71, 63
    s_lshl1_add_u32 s71, s71, 0
    s_mul_i32 s79, s71, 1536
    s_mov_b32 s68, 66048
    s_cmp_ge_u32 s71, 43
    s_cselect_b32 s70, 66048, 0
    s_add_u32 s79, s79, s70
    s_cmp_ge_u32 s71, 86
    s_cselect_b32 s68, 64512, s68
    s_cselect_b32 s70, 66048, 0
    s_add_u32 s79, s79, s70
    s_add_u32 s71, s97, 60
    s_and_b32 s71, s71, 63
    s_lshl1_add_u32 s71, s71, 1
    s_mul_i32 s69, s71, 1536
    s_cmp_ge_u32 s71, 43
    s_cselect_b32 s70, 66048, 0
    s_add_u32 s69, s69, s70
    s_cmp_ge_u32 s71, 86
    s_cselect_b32 s70, 66048, 0
    s_add_u32 s69, s69, s70
    s_sub_u32 s69, s69, s79
    s_sub_u32 s70, s68, s81
    s_mov_b32 s81, s68
    s_mov_b32 exec_lo, 0xff00ff00
    s_mov_b32 exec_hi, 0xff00ff00
    v_add_u32 v1, s70, v1
    s_mov_b64 exec, -1
    s_sub_u32 s70, s69, s83
    s_mov_b32 s83, s69
    s_mov_b32 exec_lo, 0xffff0000
    s_mov_b32 exec_hi, 0xffff0000
    v_add_u32 v1, s70, v1
    s_mov_b64 exec, -1
    v_smfmac_f32_16x16x64_bf16 v[28:31], v[16:19], v[120:127], v7
    s_waitcnt vmcnt(11)
    s_cmp_lg_u32 s85, 6
    s_cbranch_scc1 L_skip22
    s_call_b64 s[100:101], L_burst_w1
L_skip22:
    buffer_load_dwordx4 v[64:67], v2, s[36:39], s78 offen offset:0 nt
    s_waitcnt vmcnt(11)
    buffer_load_dwordx4 v[68:71], v2, s[36:39], s78 offen offset:768 nt
    v_and_b32_dpp v12, v47, v8 quad_perm:[3,3,3,3] row_mask:0xf bank_mask:0xf
    v_and_b32_dpp v13, v46, v9 quad_perm:[0,0,0,0] row_mask:0xf bank_mask:0xf
    v_and_b32_dpp v14, v47, v10 quad_perm:[3,3,3,3] row_mask:0xf bank_mask:0xf
    v_and_b32_dpp v15, v46, v11 quad_perm:[0,0,0,0] row_mask:0xf bank_mask:0xf
    s_nop 1
    v_smfmac_f32_16x16x64_bf16 v[20:23], v[12:15], v[112:119], v7
    s_waitcnt vmcnt(11)
    buffer_load_dwordx4 v[192:195], v1, s[36:39], s79 offen offset:0 nt
    s_waitcnt vmcnt(11)
    s_cmp_lg_u32 s85, 7
    s_cbranch_scc1 L_skip23
    s_call_b64 s[100:101], L_burst_w1
L_skip23:
    buffer_load_dwordx4 v[196:199], v1, s[36:39], s79 offen offset:768 nt
    v_smfmac_f32_16x16x64_bf16 v[24:27], v[12:15], v[104:111], v7
    s_waitcnt vmcnt(11)
    buffer_load_dwordx4 v[176:179], v2, s[36:39], s78 offen offset:128 nt
    s_waitcnt vmcnt(11)
    buffer_load_dwordx4 v[180:183], v2, s[36:39], s78 offen offset:896 nt
    v_smfmac_f32_16x16x64_bf16 v[28:31], v[12:15], v[96:103], v7
    s_waitcnt vmcnt(11)
    buffer_load_dwordx4 v[160:163], v1, s[36:39], s79 offen offset:128 nt
    s_waitcnt vmcnt(11)
    buffer_load_dwordx4 v[164:167], v1, s[36:39], s79 offen offset:896 nt
    v_and_b32_dpp v16, v47, v8 quad_perm:[2,2,2,2] row_mask:0xf bank_mask:0xf
    v_and_b32_dpp v17, v46, v9 quad_perm:[1,1,1,1] row_mask:0xf bank_mask:0xf
    v_and_b32_dpp v18, v47, v10 quad_perm:[2,2,2,2] row_mask:0xf bank_mask:0xf
    v_and_b32_dpp v19, v46, v11 quad_perm:[1,1,1,1] row_mask:0xf bank_mask:0xf
    s_nop 1
    v_smfmac_f32_16x16x64_bf16 v[20:23], v[16:19], v[88:95], v7
    s_waitcnt vmcnt(11)
    buffer_load_dwordx4 v[152:155], v2, s[36:39], s78 offen offset:256 nt
    s_waitcnt vmcnt(11)
    buffer_load_dwordx4 v[156:159], v2, s[36:39], s78 offen offset:1024 nt
    v_smfmac_f32_16x16x64_bf16 v[24:27], v[16:19], v[80:87], v7
    s_waitcnt vmcnt(11)
    buffer_load_dwordx4 v[144:147], v1, s[36:39], s79 offen offset:256 nt
    s_waitcnt vmcnt(11)
    buffer_load_dwordx4 v[148:151], v1, s[36:39], s79 offen offset:1024 nt
    v_smfmac_f32_16x16x64_bf16 v[28:31], v[16:19], v[72:79], v7
L_tail:
    s_mov_b32 s91, 0
    buffer_load_dword v60, v61, s[64:67], s91 offen
    s_mov_b32 s91, 8192
    buffer_load_dword v60, v61, s[64:67], s91 offen
    s_mov_b32 s91, 16384
    buffer_load_dword v60, v61, s[64:67], s91 offen
    s_mov_b32 s91, 24576
    buffer_load_dword v60, v61, s[64:67], s91 offen
    s_lshl_b32 s91, s26, 2
    s_add_u32 s91, s91, s3
    s_mul_i32 s91, s91, 1920
    v_lshlrev_b32_e64 v57, 7, v0
    s_mov_b32 exec_lo, 0x7fff
    s_mov_b32 exec_hi, 0x0
    buffer_load_dword v60, v57, s[52:55], s91 offen
    s_mov_b64 exec, -1
    v_and_b32_dpp v12, v47, v8 quad_perm:[1,1,1,1] row_mask:0xf bank_mask:0xf
    v_and_b32_dpp v13, v46, v9 quad_perm:[2,2,2,2] row_mask:0xf bank_mask:0xf
    v_and_b32_dpp v14, v47, v10 quad_perm:[1,1,1,1] row_mask:0xf bank_mask:0xf
    v_and_b32_dpp v15, v46, v11 quad_perm:[2,2,2,2] row_mask:0xf bank_mask:0xf
    v_and_b32_dpp v16, v47, v8 quad_perm:[0,0,0,0] row_mask:0xf bank_mask:0xf
    v_and_b32_dpp v17, v46, v9 quad_perm:[3,3,3,3] row_mask:0xf bank_mask:0xf
    v_and_b32_dpp v18, v47, v10 quad_perm:[0,0,0,0] row_mask:0xf bank_mask:0xf
    v_and_b32_dpp v19, v46, v11 quad_perm:[3,3,3,3] row_mask:0xf bank_mask:0xf
    v_mov_b32 v136, 0
    v_mov_b32 v137, 0
    v_mov_b32 v138, 0
    v_mov_b32 v139, 0
    v_mov_b32 v140, 0
    v_mov_b32 v141, 0
    v_mov_b32 v142, 0
    v_mov_b32 v143, 0
    s_waitcnt vmcnt(15)
    v_smfmac_f32_16x16x64_bf16 v[20:23], v[12:15], v[64:71], v7
    s_waitcnt vmcnt(13)
    v_smfmac_f32_16x16x64_bf16 v[20:23], v[16:19], v[192:199], v7
    v_mov_b32 v64, 0
    v_mov_b32 v65, 0
    v_mov_b32 v66, 0
    v_mov_b32 v67, 0
    v_mov_b32 v68, 0
    v_mov_b32 v69, 0
    v_mov_b32 v70, 0
    v_mov_b32 v71, 0
    v_mov_b32 v192, 0
    v_mov_b32 v193, 0
    v_mov_b32 v194, 0
    v_mov_b32 v195, 0
    v_permlane32_swap_b32 v20, v21
    v_permlane32_swap_b32 v22, v23
    s_nop 0
    v_add_f32_dpp v20, v21, v20 row_ror:8 row_mask:0xf bank_mask:0x3
    s_nop 1
    v_add_f32_dpp v20, v22, v23 row_ror:8 row_mask:0xf bank_mask:0xc
    ds_write_b32 v63, v20 offset:0
    s_waitcnt lgkmcnt(0)
    s_barrier
    ds_read_b128 v[48:51], v32 offset:0
    ds_read_b128 v[44:47], v32 offset:16
    s_waitcnt lgkmcnt(0)
    v_pk_add_f32 v[48:49], v[48:49], v[50:51]
    v_pk_add_f32 v[44:45], v[44:45], v[46:47]
    v_add_f32 v48, v48, v49
    v_add_f32_e64 v44, v44, v45
    v_cvt_pk_bf16_f32 v56, v48, v44
    s_nop 0
    s_nop 0
    v_and_b32_dpp v196, v56, v8 row_newbcast:0 row_mask:0xf bank_mask:0xf
    v_and_b32_dpp v197, v56, v9 row_newbcast:0 row_mask:0xf bank_mask:0xf
    v_and_b32_dpp v198, v56, v10 row_newbcast:0 row_mask:0xf bank_mask:0xf
    v_and_b32_dpp v199, v56, v11 row_newbcast:0 row_mask:0xf bank_mask:0xf
    v_and_b32_dpp v52, v56, v8 row_newbcast:1 row_mask:0xf bank_mask:0xf
    v_and_b32_dpp v53, v56, v9 row_newbcast:1 row_mask:0xf bank_mask:0xf
    v_smfmac_f32_16x16x64_bf16 v[136:139], v[196:199], a[240:247], v7
    v_and_b32_dpp v54, v56, v10 row_newbcast:1 row_mask:0xf bank_mask:0xf
    v_smfmac_f32_16x16x64_bf16 v[140:143], v[196:199], a[248:255], v7
    v_and_b32_dpp v55, v56, v11 row_newbcast:1 row_mask:0xf bank_mask:0xf
    v_smfmac_f32_16x16x64_bf16 v[64:67], v[196:199], a[0:7], v7
    v_smfmac_f32_16x16x64_bf16 v[68:71], v[196:199], a[8:15], v7
    v_smfmac_f32_16x16x64_bf16 v[192:195], v[196:199], a[16:23], v7
    v_smfmac_f32_16x16x64_bf16 v[136:139], v[52:55], a[24:31], v7
    v_smfmac_f32_16x16x64_bf16 v[140:143], v[52:55], a[32:39], v7
    v_smfmac_f32_16x16x64_bf16 v[64:67], v[52:55], a[40:47], v7
    v_smfmac_f32_16x16x64_bf16 v[68:71], v[52:55], a[48:55], v7
    v_smfmac_f32_16x16x64_bf16 v[192:195], v[52:55], a[56:63], v7
    s_waitcnt vmcnt(11)
    v_smfmac_f32_16x16x64_bf16 v[24:27], v[12:15], v[176:183], v7
    s_waitcnt vmcnt(9)
    v_smfmac_f32_16x16x64_bf16 v[24:27], v[16:19], v[160:167], v7
    s_nop 7
    v_permlane32_swap_b32 v24, v25
    v_permlane32_swap_b32 v26, v27
    s_nop 0
    v_add_f32_dpp v24, v25, v24 row_ror:8 row_mask:0xf bank_mask:0x3
    s_nop 0
    s_nop 0
    v_add_f32_dpp v24, v26, v27 row_ror:8 row_mask:0xf bank_mask:0xc
    ds_write_b32 v63, v24 offset:1024
    s_waitcnt lgkmcnt(0)
    s_barrier
    ds_read_b128 v[48:51], v32 offset:1024
    ds_read_b128 v[44:47], v32 offset:1040
    s_waitcnt lgkmcnt(0)
    v_pk_add_f32 v[48:49], v[48:49], v[50:51]
    v_pk_add_f32 v[44:45], v[44:45], v[46:47]
    v_add_f32 v48, v48, v49
    v_add_f32_e64 v44, v44, v45
    v_cvt_pk_bf16_f32 v57, v48, v44
    s_nop 0
    s_nop 0
    v_and_b32_dpp v196, v57, v8 row_newbcast:0 row_mask:0xf bank_mask:0xf
    v_and_b32_dpp v197, v57, v9 row_newbcast:0 row_mask:0xf bank_mask:0xf
    v_and_b32_dpp v198, v57, v10 row_newbcast:0 row_mask:0xf bank_mask:0xf
    v_and_b32_dpp v199, v57, v11 row_newbcast:0 row_mask:0xf bank_mask:0xf
    v_and_b32_dpp v52, v57, v8 row_newbcast:1 row_mask:0xf bank_mask:0xf
    v_and_b32_dpp v53, v57, v9 row_newbcast:1 row_mask:0xf bank_mask:0xf
    v_smfmac_f32_16x16x64_bf16 v[136:139], v[196:199], a[64:71], v7
    v_and_b32_dpp v54, v57, v10 row_newbcast:1 row_mask:0xf bank_mask:0xf
    v_smfmac_f32_16x16x64_bf16 v[140:143], v[196:199], a[72:79], v7
    v_and_b32_dpp v55, v57, v11 row_newbcast:1 row_mask:0xf bank_mask:0xf
    v_smfmac_f32_16x16x64_bf16 v[64:67], v[196:199], a[80:87], v7
    v_smfmac_f32_16x16x64_bf16 v[68:71], v[196:199], a[88:95], v7
    v_smfmac_f32_16x16x64_bf16 v[192:195], v[196:199], a[96:103], v7
    v_smfmac_f32_16x16x64_bf16 v[136:139], v[52:55], a[104:111], v7
    v_smfmac_f32_16x16x64_bf16 v[140:143], v[52:55], a[112:119], v7
    v_smfmac_f32_16x16x64_bf16 v[64:67], v[52:55], a[120:127], v7
    v_smfmac_f32_16x16x64_bf16 v[68:71], v[52:55], a[128:135], v7
    v_smfmac_f32_16x16x64_bf16 v[192:195], v[52:55], a[136:143], v7
    s_waitcnt vmcnt(7)
    v_smfmac_f32_16x16x64_bf16 v[28:31], v[12:15], v[152:159], v7
    s_waitcnt vmcnt(5)
    v_smfmac_f32_16x16x64_bf16 v[28:31], v[16:19], v[144:151], v7
    s_nop 7
    v_permlane32_swap_b32 v28, v29
    v_permlane32_swap_b32 v30, v31
    s_nop 0
    v_add_f32_dpp v28, v29, v28 row_ror:8 row_mask:0xf bank_mask:0x3
    s_nop 0
    s_nop 0
    v_add_f32_dpp v28, v30, v31 row_ror:8 row_mask:0xf bank_mask:0xc
    ds_write_b32 v63, v28 offset:2048
    s_waitcnt lgkmcnt(0)
    s_barrier
    ds_read_b128 v[48:51], v32 offset:2048
    ds_read_b128 v[44:47], v32 offset:2064
    s_waitcnt lgkmcnt(0)
    v_pk_add_f32 v[48:49], v[48:49], v[50:51]
    v_pk_add_f32 v[44:45], v[44:45], v[46:47]
    v_add_f32 v48, v48, v49
    v_add_f32_e64 v44, v44, v45
    v_cvt_pk_bf16_f32 v56, v48, v44
    s_nop 0
    s_nop 0
    v_and_b32_dpp v196, v56, v8 row_newbcast:0 row_mask:0xf bank_mask:0xf
    v_and_b32_dpp v197, v56, v9 row_newbcast:0 row_mask:0xf bank_mask:0xf
    v_and_b32_dpp v198, v56, v10 row_newbcast:0 row_mask:0xf bank_mask:0xf
    v_and_b32_dpp v199, v56, v11 row_newbcast:0 row_mask:0xf bank_mask:0xf
    v_and_b32_dpp v52, v56, v8 row_newbcast:1 row_mask:0xf bank_mask:0xf
    v_and_b32_dpp v53, v56, v9 row_newbcast:1 row_mask:0xf bank_mask:0xf
    v_smfmac_f32_16x16x64_bf16 v[136:139], v[196:199], a[144:151], v7
    v_and_b32_dpp v54, v56, v10 row_newbcast:1 row_mask:0xf bank_mask:0xf
    v_smfmac_f32_16x16x64_bf16 v[140:143], v[196:199], a[152:159], v7
    v_and_b32_dpp v55, v56, v11 row_newbcast:1 row_mask:0xf bank_mask:0xf
    v_smfmac_f32_16x16x64_bf16 v[64:67], v[196:199], a[160:167], v7
    v_smfmac_f32_16x16x64_bf16 v[68:71], v[196:199], a[168:175], v7
    v_smfmac_f32_16x16x64_bf16 v[192:195], v[196:199], a[176:183], v7
    v_smfmac_f32_16x16x64_bf16 v[136:139], v[52:55], a[184:191], v7
    v_smfmac_f32_16x16x64_bf16 v[140:143], v[52:55], a[192:199], v7
    v_smfmac_f32_16x16x64_bf16 v[64:67], v[52:55], a[200:207], v7
    v_smfmac_f32_16x16x64_bf16 v[68:71], v[52:55], a[208:215], v7
    v_smfmac_f32_16x16x64_bf16 v[192:195], v[52:55], a[216:223], v7
    s_nop 0
    s_nop 3
    v_mov_b32_dpp v136, v140 quad_perm:[0,1,2,3] row_mask:0xc bank_mask:0xf
    v_mov_b32_dpp v137, v141 quad_perm:[0,1,2,3] row_mask:0xc bank_mask:0xf
    v_mov_b32_dpp v138, v142 quad_perm:[0,1,2,3] row_mask:0xc bank_mask:0xf
    v_mov_b32_dpp v139, v143 quad_perm:[0,1,2,3] row_mask:0xc bank_mask:0xf
    ds_write_b128 v33, v[136:139] offset:5120
    v_mov_b32_dpp v64, v68 quad_perm:[0,1,2,3] row_mask:0xc bank_mask:0xf
    v_mov_b32_dpp v65, v69 quad_perm:[0,1,2,3] row_mask:0xc bank_mask:0xf
    v_mov_b32_dpp v66, v70 quad_perm:[0,1,2,3] row_mask:0xc bank_mask:0xf
    v_mov_b32_dpp v67, v71 quad_perm:[0,1,2,3] row_mask:0xc bank_mask:0xf
    ds_write_b128 v33, v[64:67] offset:6144
    ds_write_b128 v33, v[192:195] offset:7168
    s_waitcnt lgkmcnt(0)
    s_barrier
    ds_read_b128 v[176:179], v34 offset:5120
    ds_read_b128 v[180:183], v34 offset:8192
    ds_read_b128 v[160:163], v34 offset:11264
    ds_read_b128 v[164:167], v34 offset:14336
    v_mov_b32 v20, 0
    v_mov_b32 v21, 0
    v_mov_b32 v22, 0
    v_mov_b32 v23, 0
    v_mov_b32 v24, 0
    v_mov_b32 v25, 0
    v_mov_b32 v26, 0
    v_mov_b32 v27, 0
    v_mov_b32 v28, 0
    v_mov_b32 v29, 0
    v_mov_b32 v30, 0
    v_mov_b32 v31, 0
    s_nop 0
    s_waitcnt lgkmcnt(0)
    v_pk_add_f32 v[192:193], v[176:177], v[180:181]
    v_pk_add_f32 v[196:197], v[160:161], v[164:165]
    v_pk_add_f32 v[194:195], v[178:179], v[182:183]
    v_pk_add_f32 v[198:199], v[162:163], v[166:167]
    v_pk_add_f32 v[192:193], v[192:193], v[196:197]
    v_pk_add_f32 v[194:195], v[194:195], v[198:199]
    v_and_or_b32 v192, v192, v4, v58
    buffer_store_dwordx4 v[192:195], v62, s[64:67], 0 offen sc1
    s_cmp_lg_u32 s3, 3
    s_cbranch_scc1 L_latew
    v_lshlrev_b32_e64 v43, 16, v43
L_red1:
    buffer_load_dwordx4 v[176:179], v36, s[64:67], s40 offen sc1
    buffer_load_dwordx4 v[180:183], v36, s[64:67], s41 offen sc1
    buffer_load_dwordx4 v[160:163], v36, s[64:67], s42 offen sc1
    buffer_load_dwordx4 v[164:167], v36, s[64:67], s43 offen sc1
    s_add_u32 s98, s98, 1
    s_cmp_gt_u32 s98, 200000
    s_cbranch_scc1 L_end
    s_waitcnt vmcnt(0)
    v_xor_b32 v176, v58, v176
    v_xor_b32 v180, v58, v180
    v_xor_b32 v160, v58, v160
    v_xor_b32_e64 v164, v58, v164
    v_or3_b32 v48, v176, v180, v4
    v_or3_b32 v48, v160, v164, v48
    v_cmp_ne_u32 vcc, v48, v4
    s_cbranch_vccnz L_red1
    v_pk_add_f32 v[192:193], v[176:177], v[180:181]
    v_pk_add_f32 v[196:197], v[160:161], v[164:165]
    v_pk_add_f32 v[194:195], v[178:179], v[182:183]
    v_pk_add_f32 v[198:199], v[162:163], v[166:167]
    v_pk_add_f32 v[192:193], v[192:193], v[196:197]
    v_pk_add_f32 v[194:195], v[194:195], v[198:199]
    s_nop 0
    v_add_f32_dpp v48, v192, v192 row_ror:8 row_mask:0xf bank_mask:0x3
    v_add_f32_dpp v49, v194, v194 row_ror:8 row_mask:0xf bank_mask:0x3
    s_nop 0
    v_add_f32_dpp v48, v193, v193 row_ror:8 row_mask:0xf bank_mask:0xc
    v_add_f32_dpp v49, v195, v195 row_ror:8 row_mask:0xf bank_mask:0xc
    s_nop 1
    v_permlane16_swap_b32 v48, v49
    v_add_f32 v48, v48, v49
    v_mov_b32 v49, v48
    s_nop 1
    v_permlane32_swap_b32 v48, v49
    v_add_f32_e64 v48, v48, v49
    v_cvt_pk_bf16_f32 v48, v48, v48
    v_lshlrev_b32 v48, 16, v48
    v_add_f32 v43, v43, v48
    v_cvt_pk_bf16_f32 v43, v43, v43
    v_lshl_or_b32 v48, v43, 16, v3
    buffer_store_dword v48, v61, s[64:67], 0 offen sc1
    buffer_store_dword v48, v61, s[64:67], s74 offen sc1
    buffer_store_dword v48, v61, s[64:67], s75 offen sc1
    buffer_store_dword v48, v61, s[64:67], s76 offen sc1
    v_lshlrev_b32 v43, 16, v43
L_latew:
    s_mov_b32 s84, 0
    buffer_load_dwordx4 a[240:243], v5, s[52:55], s84 offen offset:0
    s_mov_b32 s84, 10240
    buffer_load_dwordx4 a[244:247], v5, s[52:55], s84 offen offset:0
    s_nop 0
    s_mov_b32 s84, 0
    buffer_load_dwordx4 a[248:251], v5, s[52:55], s84 offen offset:128
    s_mov_b32 s84, 10240
    buffer_load_dwordx4 a[252:255], v5, s[52:55], s84 offen offset:128
    s_mov_b32 s84, 20480
    buffer_load_dwordx4 a[8:11], v5, s[52:55], s84 offen offset:0
    s_mov_b32 s84, 30720
    buffer_load_dwordx4 a[12:15], v5, s[52:55], s84 offen offset:0
    s_mov_b32 s84, 20480
    buffer_load_dwordx4 a[16:19], v5, s[52:55], s84 offen offset:128
    s_mov_b32 s84, 30720
    buffer_load_dwordx4 a[20:23], v5, s[52:55], s84 offen offset:128
    s_mov_b32 s84, 40960
    buffer_load_dwordx4 a[32:35], v5, s[52:55], s84 offen offset:0
    s_mov_b32 s84, 51200
    buffer_load_dwordx4 a[36:39], v5, s[52:55], s84 offen offset:0
    s_mov_b32 s84, 40960
    buffer_load_dwordx4 a[40:43], v5, s[52:55], s84 offen offset:128
    s_mov_b32 s84, 51200
    buffer_load_dwordx4 a[44:47], v5, s[52:55], s84 offen offset:128
    s_waitcnt vmcnt(12)
    s_cmp_ge_u32 s3, 2
    s_cbranch_scc1 L_hpoll0
    s_add_u32 s84, s1, 0
    buffer_load_dwordx4 a[0:3], v5, s[52:55], s84 offen offset:0
    s_add_u32 s84, s1, 10240
    buffer_load_dwordx4 a[4:7], v5, s[52:55], s84 offen offset:0
    s_add_u32 s84, s1, 20480
    buffer_load_dwordx4 a[24:27], v5, s[52:55], s84 offen offset:0
    s_add_u32 s84, s1, 30720
    buffer_load_dwordx4 a[28:31], v5, s[52:55], s84 offen offset:0
    s_add_u32 s84, s1, 40960
    buffer_load_dwordx4 a[48:51], v5, s[52:55], s84 offen offset:0
    s_add_u32 s84, s1, 51200
    buffer_load_dwordx4 a[52:55], v5, s[52:55], s84 offen offset:0
L_hpoll0:
    s_barrier
L_hpoll:
    buffer_load_dwordx2 v[152:153], v38, s[64:67], s32 offen sc1
    buffer_load_dwordx2 v[154:155], v38, s[64:67], s33 offen sc1
    buffer_load_dwordx2 v[156:157], v38, s[64:67], s34 offen sc1
    buffer_load_dwordx2 v[158:159], v38, s[64:67], s35 offen sc1
    buffer_load_dwordx2 v[144:145], v39, s[64:67], 0 offen offset:2048 sc1
    s_add_u32 s98, s98, 1
    s_cmp_gt_u32 s98, 200000
    s_cbranch_scc1 L_end
    s_waitcnt vmcnt(0)
L_hcheck:
    v_xor_b32 v152, v59, v152
    v_xor_b32 v154, v59, v154
    v_xor_b32 v156, v59, v156
    v_xor_b32 v158, v59, v158
    v_xor_b32_e64 v144, v59, v144
    v_or3_b32 v48, v152, v154, v156
    v_or3_b32 v48, v158, v144, v48
    v_cmp_ne_u16 vcc, 0, v48
    s_cbranch_vccnz L_hpoll
    buffer_load_dword v60, v41, s[64:67], 0 offen
    v_pk_add_f32 v[48:49], v[152:153], v[154:155]
    v_pk_add_f32 v[50:51], v[156:157], v[158:159]
    v_pk_add_f32 v[48:49], v[48:49], v[144:145]
    v_pk_add_f32 v[48:49], v[48:49], v[50:51]
    v_add_f32_e64 v48, v48, v49
    v_mov_b32 v50, 0xbacccccd
    s_nop 0
    v_add_f32_dpp v48, v48, v48 quad_perm:[1,0,3,2] row_mask:0xf bank_mask:0xf
    s_nop 1
    v_add_f32_dpp v48, v48, v48 quad_perm:[2,3,0,1] row_mask:0xf bank_mask:0xf
    s_nop 0
    s_nop 0
    v_add_f32_dpp v48, v48, v48 row_half_mirror row_mask:0xf bank_mask:0xf
    s_nop 0
    s_nop 0
    v_add_f32_dpp v48, v48, v48 row_mirror row_mask:0xf bank_mask:0xf
    s_nop 0
    s_nop 0
    v_add_f32_dpp v48, v48, v48 row_bcast:15 row_mask:0xa bank_mask:0xf
    s_nop 0
    s_nop 0
    v_add_f32_dpp v48, v48, v48 row_bcast:31 row_mask:0xc bank_mask:0xf
    s_nop 0
    v_readlane_b32 s94, v48, 63
    s_nop 1
    v_mul_f32 v48, s94, v50
    v_mul_f32 v49, s94, v50
    v_pk_add_f32 v[50:51], v[152:153], v[48:49]
    v_pk_add_f32 v[138:139], v[154:155], v[48:49]
    v_pk_mul_f32 v[50:51], v[50:51], v[50:51]
    v_pk_add_f32 v[140:141], v[156:157], v[48:49]
    v_pk_fma_f32 v[50:51], v[138:139], v[138:139], v[50:51]
    v_pk_add_f32 v[142:143], v[158:159], v[48:49]
    v_pk_fma_f32 v[50:51], v[140:141], v[140:141], v[50:51]
    v_pk_add_f32 v[138:139], v[144:145], v[48:49]
    v_pk_fma_f32 v[50:51], v[142:143], v[142:143], v[50:51]
    v_pk_fma_f32 v[50:51], v[138:139], v[138:139], v[50:51]
    v_add_f32_e64 v50, v50, v51
    v_cvt_pk_bf16_f32 v48, v48, v48
    v_lshlrev_b32_e64 v49, 16, v48
    v_add_f32_dpp v50, v50, v50 quad_perm:[1,0,3,2] row_mask:0xf bank_mask:0xf
    v_lshlrev_b32_e64 v48, 16, v48
    v_pk_add_f32 v[136:137], v[152:153], v[48:49]
    v_add_f32_dpp v50, v50, v50 quad_perm:[2,3,0,1] row_mask:0xf bank_mask:0xf
    v_pk_add_f32 v[64:65], v[144:145], v[48:49]
    v_cvt_pk_bf16_f32 v138, v136, v137
    v_add_f32_dpp v50, v50, v50 row_half_mirror row_mask:0xf bank_mask:0xf
    v_cvt_pk_bf16_f32 v139, v64, v65
    v_lshlrev_b32_e64 v136, 16, v138
    v_add_f32_dpp v50, v50, v50 row_mirror row_mask:0xf bank_mask:0xf
    v_and_b32 v137, 0xffff0000, v138
    v_lshlrev_b32_e64 v64, 16, v139
    v_add_f32_dpp v50, v50, v50 row_bcast:15 row_mask:0xa bank_mask:0xf
    v_and_b32 v65, 0xffff0000, v139
    v_mov_b32 v52, 0x3acccccd
    v_add_f32_dpp v50, v50, v50 row_bcast:31 row_mask:0xc bank_mask:0xf
    s_nop 0
    v_readlane_b32 s94, v50, 63
    s_nop 1
    v_mul_f32_e64 v48, s94, v52
    v_cvt_pk_bf16_f32 v48, v48, v48
    v_lshlrev_b32_e64 v48, 16, v48
    v_add_f32 v48, 0x3727c5ac, v48
    v_cvt_pk_bf16_f32 v48, v48, v48
    v_lshlrev_b32 v48, 16, v48
    v_sqrt_f32 v48, v48
    s_nop 0
    v_cvt_pk_bf16_f32 v48, v48, v48
    v_lshlrev_b32 v48, 16, v48
    v_rcp_f32 v48, v48
    s_nop 0
    v_mul_f32 v136, v136, v48
    v_mul_f32 v137, v137, v48
    v_cvt_pk_bf16_f32 v44, v136, v137
    v_mul_f32 v64, v64, v48
    v_mul_f32 v65, v65, v48
    v_mov_b32_dpp v45, v44 row_half_mirror row_mask:0xf bank_mask:0xf
    v_cvt_pk_bf16_f32 v46, v64, v65
    s_nop 0
    s_nop 0
    v_mov_b32_dpp v47, v46 row_half_mirror row_mask:0xf bank_mask:0xf
    v_and_b32_dpp v12, v44, v8 quad_perm:[0,0,0,0] row_mask:0xf bank_mask:0xf
    v_and_b32_dpp v13, v45, v9 quad_perm:[3,3,3,3] row_mask:0xf bank_mask:0xf
    v_and_b32_dpp v14, v44, v10 quad_perm:[0,0,0,0] row_mask:0xf bank_mask:0xf
    v_and_b32_dpp v15, v45, v11 quad_perm:[3,3,3,3] row_mask:0xf bank_mask:0xf
    v_and_b32_dpp v16, v44, v8 quad_perm:[1,1,1,1] row_mask:0xf bank_mask:0xf
    v_and_b32_dpp v17, v45, v9 quad_perm:[2,2,2,2] row_mask:0xf bank_mask:0xf
    v_smfmac_f32_16x16x64_bf16 v[20:23], v[12:15], a[224:231], v7
    v_and_b32_dpp v18, v44, v10 quad_perm:[1,1,1,1] row_mask:0xf bank_mask:0xf
    v_and_b32_dpp v19, v45, v11 quad_perm:[2,2,2,2] row_mask:0xf bank_mask:0xf
    v_and_b32_dpp v12, v44, v8 quad_perm:[2,2,2,2] row_mask:0xf bank_mask:0xf
    v_and_b32_dpp v13, v45, v9 quad_perm:[1,1,1,1] row_mask:0xf bank_mask:0xf
    v_smfmac_f32_16x16x64_bf16 v[20:23], v[16:19], a[232:239], v7
    v_and_b32_dpp v14, v44, v10 quad_perm:[2,2,2,2] row_mask:0xf bank_mask:0xf
    v_and_b32_dpp v15, v45, v11 quad_perm:[1,1,1,1] row_mask:0xf bank_mask:0xf
    v_and_b32_dpp v16, v44, v8 quad_perm:[3,3,3,3] row_mask:0xf bank_mask:0xf
    v_and_b32_dpp v17, v45, v9 quad_perm:[0,0,0,0] row_mask:0xf bank_mask:0xf
    v_smfmac_f32_16x16x64_bf16 v[20:23], v[12:15], v[248:255], v7
    v_and_b32_dpp v18, v44, v10 quad_perm:[3,3,3,3] row_mask:0xf bank_mask:0xf
    v_and_b32_dpp v19, v45, v11 quad_perm:[0,0,0,0] row_mask:0xf bank_mask:0xf
    v_and_b32_dpp v12, v45, v8 quad_perm:[3,3,3,3] row_mask:0xf bank_mask:0xf
    v_and_b32_dpp v13, v44, v9 quad_perm:[0,0,0,0] row_mask:0xf bank_mask:0xf
    v_smfmac_f32_16x16x64_bf16 v[20:23], v[16:19], v[240:247], v7
    v_and_b32_dpp v14, v45, v10 quad_perm:[3,3,3,3] row_mask:0xf bank_mask:0xf
    v_and_b32_dpp v15, v44, v11 quad_perm:[0,0,0,0] row_mask:0xf bank_mask:0xf
    v_and_b32_dpp v16, v45, v8 quad_perm:[2,2,2,2] row_mask:0xf bank_mask:0xf
    v_and_b32_dpp v17, v44, v9 quad_perm:[1,1,1,1] row_mask:0xf bank_mask:0xf
    v_smfmac_f32_16x16x64_bf16 v[20:23], v[12:15], v[232:239], v7
    v_and_b32_dpp v18, v45, v10 quad_perm:[2,2,2,2] row_mask:0xf bank_mask:0xf
    v_and_b32_dpp v19, v44, v11 quad_perm:[1,1,1,1] row_mask:0xf bank_mask:0xf
    v_and_b32_dpp v12, v45, v8 quad_perm:[1,1,1,1] row_mask:0xf bank_mask:0xf
    v_and_b32_dpp v13, v44, v9 quad_perm:[2,2,2,2] row_mask:0xf bank_mask:0xf
    v_smfmac_f32_16x16x64_bf16 v[20:23], v[16:19], v[224:231], v7
    v_and_b32_dpp v14, v45, v10 quad_perm:[1,1,1,1] row_mask:0xf bank_mask:0xf
    v_and_b32_dpp v15, v44, v11 quad_perm:[2,2,2,2] row_mask:0xf bank_mask:0xf
    v_and_b32_dpp v16, v45, v8 quad_perm:[0,0,0,0] row_mask:0xf bank_mask:0xf
    v_and_b32_dpp v17, v44, v9 quad_perm:[3,3,3,3] row_mask:0xf bank_mask:0xf
    v_smfmac_f32_16x16x64_bf16 v[20:23], v[12:15], v[216:223], v7
    v_and_b32_dpp v18, v45, v10 quad_perm:[0,0,0,0] row_mask:0xf bank_mask:0xf
    v_and_b32_dpp v19, v44, v11 quad_perm:[3,3,3,3] row_mask:0xf bank_mask:0xf
    v_and_b32_dpp v12, v46, v8 quad_perm:[0,0,0,0] row_mask:0xf bank_mask:0xf
    v_and_b32_dpp v13, v47, v9 quad_perm:[3,3,3,3] row_mask:0xf bank_mask:0xf
    v_smfmac_f32_16x16x64_bf16 v[20:23], v[16:19], v[208:215], v7
    v_and_b32_dpp v14, v46, v10 quad_perm:[0,0,0,0] row_mask:0xf bank_mask:0xf
    v_and_b32_dpp v15, v47, v11 quad_perm:[3,3,3,3] row_mask:0xf bank_mask:0xf
    v_and_b32_dpp v16, v46, v8 quad_perm:[1,1,1,1] row_mask:0xf bank_mask:0xf
    v_and_b32_dpp v17, v47, v9 quad_perm:[2,2,2,2] row_mask:0xf bank_mask:0xf
    v_smfmac_f32_16x16x64_bf16 v[20:23], v[12:15], v[200:207], v7
    v_and_b32_dpp v18, v46, v10 quad_perm:[1,1,1,1] row_mask:0xf bank_mask:0xf
    v_and_b32_dpp v19, v47, v11 quad_perm:[2,2,2,2] row_mask:0xf bank_mask:0xf
    s_nop 0
    s_nop 0
    v_smfmac_f32_16x16x64_bf16 v[20:23], v[16:19], v[184:191], v7
    v_mov_b32 v56, 0xbfb8aa3b
    s_nop 6
    v_permlane32_swap_b32 v20, v21
    v_permlane32_swap_b32 v22, v23
    s_nop 0
    v_add_f32_dpp v20, v21, v20 row_ror:8 row_mask:0xf bank_mask:0x3
    s_nop 0
    s_nop 0
    v_add_f32_dpp v20, v22, v23 row_ror:8 row_mask:0xf bank_mask:0xc
    ds_write_b32 v63, v20 offset:17408
    s_waitcnt lgkmcnt(0)
    s_barrier
    ds_read_b128 v[48:51], v40 offset:17408
    ds_read_b128 v[52:55], v40 offset:17424
    v_mov_b32 v20, 0
    v_mov_b32 v21, 0
    v_mov_b32 v22, 0
    v_mov_b32 v23, 0
    s_add_u32 s40, s40, 786432
    s_add_u32 s41, s41, 786432
    s_add_u32 s42, s42, 786432
    s_add_u32 s43, s43, 786432
    s_waitcnt lgkmcnt(0)
    v_pk_add_f32 v[48:49], v[48:49], v[50:51]
    v_pk_add_f32 v[52:53], v[52:53], v[54:55]
    v_add_f32 v48, v48, v49
    v_add_f32_e64 v52, v52, v53
    v_cvt_pk_bf16_f32 v49, v48, v52
    v_lshlrev_b32_e64 v48, 16, v49
    v_and_b32 v49, 0xffff0000, v49
    v_mul_f32 v50, v48, v56
    v_mul_f32 v51, v49, v56
    v_exp_f32 v50, v50
    v_exp_f32 v51, v51
    v_add_f32 v50, 1.0, v50
    v_add_f32 v51, 1.0, v51
    v_rcp_f32 v50, v50
    v_rcp_f32 v51, v51
    v_mul_f32 v48, v48, v50
    v_mul_f32 v49, v49, v51
    v_cvt_pk_bf16_f32 v44, v48, v49
    s_nop 0
    s_nop 0
    v_and_b32_dpp v12, v44, v8 quad_perm:[0,0,0,0] row_mask:0xf bank_mask:0xf
    v_and_b32_dpp v13, v44, v9 quad_perm:[0,0,0,0] row_mask:0xf bank_mask:0xf
    v_and_b32_dpp v14, v44, v10 quad_perm:[0,0,0,0] row_mask:0xf bank_mask:0xf
    v_and_b32_dpp v15, v44, v11 quad_perm:[0,0,0,0] row_mask:0xf bank_mask:0xf
    v_and_b32_dpp v16, v44, v8 quad_perm:[1,1,1,1] row_mask:0xf bank_mask:0xf
    v_and_b32_dpp v17, v44, v9 quad_perm:[1,1,1,1] row_mask:0xf bank_mask:0xf
    v_smfmac_f32_16x16x64_bf16 v[20:23], v[12:15], a[240:247], v7
    v_and_b32_dpp v18, v44, v10 quad_perm:[1,1,1,1] row_mask:0xf bank_mask:0xf
    v_smfmac_f32_16x16x64_bf16 v[24:27], v[12:15], a[248:255], v7
    v_and_b32_dpp v19, v44, v11 quad_perm:[1,1,1,1] row_mask:0xf bank_mask:0xf
    v_smfmac_f32_16x16x64_bf16 v[28:31], v[12:15], a[0:7], v7
    v_and_b32_dpp v12, v44, v8 quad_perm:[2,2,2,2] row_mask:0xf bank_mask:0xf
    v_and_b32_dpp v13, v44, v9 quad_perm:[2,2,2,2] row_mask:0xf bank_mask:0xf
    v_smfmac_f32_16x16x64_bf16 v[20:23], v[16:19], a[8:15], v7
    v_and_b32_dpp v14, v44, v10 quad_perm:[2,2,2,2] row_mask:0xf bank_mask:0xf
    v_smfmac_f32_16x16x64_bf16 v[24:27], v[16:19], a[16:23], v7
    v_and_b32_dpp v15, v44, v11 quad_perm:[2,2,2,2] row_mask:0xf bank_mask:0xf
    v_smfmac_f32_16x16x64_bf16 v[28:31], v[16:19], a[24:31], v7
    s_nop 0
    v_smfmac_f32_16x16x64_bf16 v[20:23], v[12:15], a[32:39], v7
    v_smfmac_f32_16x16x64_bf16 v[24:27], v[12:15], a[40:47], v7
    v_smfmac_f32_16x16x64_bf16 v[28:31], v[12:15], a[48:55], v7
    s_nop 6
    v_permlane32_swap_b32 v20, v24
    v_permlane32_swap_b32 v21, v25
    v_permlane32_swap_b32 v22, v26
    v_permlane32_swap_b32 v23, v27
    v_add_f32_dpp v20, v24, v20 row_ror:8 row_mask:0xf bank_mask:0x3
    v_add_f32_dpp v21, v25, v21 row_ror:8 row_mask:0xf bank_mask:0x3
    v_add_f32_dpp v22, v26, v22 row_ror:8 row_mask:0xf bank_mask:0x3
    v_add_f32_dpp v23, v27, v23 row_ror:8 row_mask:0xf bank_mask:0x3
    v_permlane32_swap_b32 v24, v28
    v_permlane32_swap_b32 v25, v29
    v_permlane32_swap_b32 v26, v30
    v_permlane32_swap_b32 v27, v31
    v_add_f32_dpp v20, v24, v28 row_ror:8 row_mask:0xc bank_mask:0xc
    v_add_f32_dpp v21, v25, v29 row_ror:8 row_mask:0xc bank_mask:0xc
    v_add_f32_dpp v22, v26, v30 row_ror:8 row_mask:0xc bank_mask:0xc
    v_add_f32_dpp v23, v27, v31 row_ror:8 row_mask:0xc bank_mask:0xc
    v_and_or_b32 v20, v20, v4, v58
    buffer_store_dwordx4 v[20:23], v41, s[64:67], 0 offen sc1
    s_cmp_lg_u32 s3, 3
    s_cbranch_scc1 L_end
    s_cmp_ge_u32 s27, 20
    s_cbranch_scc1 L_end
    s_waitcnt vmcnt(0)
L_red2:
    buffer_load_dwordx4 v[176:179], v36, s[64:67], s40 offen sc1
    buffer_load_dwordx4 v[180:183], v36, s[64:67], s41 offen sc1
    buffer_load_dwordx4 v[160:163], v36, s[64:67], s42 offen sc1
    buffer_load_dwordx4 v[164:167], v36, s[64:67], s43 offen sc1
    s_add_u32 s98, s98, 1
    s_cmp_gt_u32 s98, 200000
    s_cbranch_scc1 L_end
    s_waitcnt vmcnt(0)
    v_xor_b32 v176, v58, v176
    v_xor_b32 v180, v58, v180
    v_xor_b32 v160, v58, v160
    v_xor_b32 v164, v58, v164
    v_or3_b32 v48, v176, v180, v4
    v_or3_b32 v48, v160, v164, v48
    v_cmp_ne_u32 vcc, v48, v4
    s_cbranch_vccnz L_red2
    v_pk_add_f32 v[192:193], v[176:177], v[180:181]
    v_pk_add_f32 v[196:197], v[160:161], v[164:165]
    v_pk_add_f32 v[194:195], v[178:179], v[182:183]
    v_pk_add_f32 v[198:199], v[162:163], v[166:167]
    v_pk_add_f32 v[192:193], v[192:193], v[196:197]
    v_pk_add_f32 v[194:195], v[194:195], v[198:199]
    s_nop 0
    v_add_f32_dpp v48, v192, v192 row_ror:8 row_mask:0xf bank_mask:0x3
    v_add_f32_dpp v49, v194, v194 row_ror:8 row_mask:0xf bank_mask:0x3
    s_nop 0
    v_add_f32_dpp v48, v193, v193 row_ror:8 row_mask:0xf bank_mask:0xc
    v_add_f32_dpp v49, v195, v195 row_ror:8 row_mask:0xf bank_mask:0xc
    s_nop 1
    v_permlane16_swap_b32 v48, v49
    v_add_f32 v48, v48, v49
    v_mov_b32 v49, v48
    s_nop 1
    v_permlane32_swap_b32 v48, v49
    v_add_f32_e64 v48, v48, v49
    v_cvt_pk_bf16_f32 v48, v48, v48
    v_lshlrev_b32 v48, 16, v48
    v_add_f32 v48, v43, v48
    v_cvt_pk_bf16_f32 v48, v48, v48
    buffer_store_short v48, v42, s[56:59], 0 offen
L_end:
    s_endpgm
L_cntwait:
    s_mov_b32 s91, 0
    buffer_load_dwordx2 v[56:57], off, s[60:63], 0 sc1
    s_add_u32 s98, s98, 1
    s_cmp_gt_u32 s98, 200000
    s_cbranch_scc1 L_end
    s_waitcnt vmcnt(0)
    v_cmp_eq_u32 vcc, 0, v56
    s_cbranch_vccnz L_cntwait
L_last:
    s_branch L_cntok
L_burst_wq:
    s_waitcnt vmcnt(10)
    s_add_u32 s84, s86, 0
    buffer_load_dwordx4 a[0:3], v3, s[40:43], s84 offen offset:0
    s_add_u32 s84, s86, 786432
    buffer_load_dwordx4 a[4:7], v3, s[40:43], s84 offen offset:0
    s_waitcnt vmcnt(10)
    s_add_u32 s84, s86, 0
    buffer_load_dwordx4 a[8:11], v3, s[40:43], s84 offen offset:128
    s_add_u32 s84, s86, 786432
    buffer_load_dwordx4 a[12:15], v3, s[40:43], s84 offen offset:128
    s_waitcnt vmcnt(10)
    s_add_u32 s84, s86, 0
    buffer_load_dwordx4 a[16:19], v3, s[40:43], s84 offen offset:256
    s_add_u32 s84, s86, 786432
    buffer_load_dwordx4 a[20:23], v3, s[40:43], s84 offen offset:256
    s_waitcnt vmcnt(10)
    s_add_u32 s84, s86, 24576
    buffer_load_dwordx4 a[24:27], v3, s[40:43], s84 offen offset:0
    s_add_u32 s84, s86, 811008
    buffer_load_dwordx4 a[28:31], v3, s[40:43], s84 offen offset:0
    s_waitcnt vmcnt(10)
    s_add_u32 s84, s86, 24576
    buffer_load_dwordx4 a[32:35], v3, s[40:43], s84 offen offset:128
    s_add_u32 s84, s86, 811008
    buffer_load_dwordx4 a[36:39], v3, s[40:43], s84 offen offset:128
    s_waitcnt vmcnt(10)
    s_add_u32 s84, s86, 24576
    buffer_load_dwordx4 a[40:43], v3, s[40:43], s84 offen offset:256
    s_add_u32 s84, s86, 811008
    buffer_load_dwordx4 a[44:47], v3, s[40:43], s84 offen offset:256
    s_waitcnt vmcnt(10)
    s_add_u32 s84, s86, 49152
    buffer_load_dwordx4 a[48:51], v3, s[40:43], s84 offen offset:0
    s_add_u32 s84, s86, 835584
    buffer_load_dwordx4 a[52:55], v3, s[40:43], s84 offen offset:0
    s_waitcnt vmcnt(10)
    s_add_u32 s84, s86, 49152
    buffer_load_dwordx4 a[56:59], v3, s[40:43], s84 offen offset:128
    s_add_u32 s84, s86, 835584
    buffer_load_dwordx4 a[60:63], v3, s[40:43], s84 offen offset:128
    s_waitcnt vmcnt(10)
    s_add_u32 s84, s86, 49152
    buffer_load_dwordx4 a[64:67], v3, s[40:43], s84 offen offset:256
    s_add_u32 s84, s86, 835584
    buffer_load_dwordx4 a[68:71], v3, s[40:43], s84 offen offset:256
    s_waitcnt vmcnt(10)
    s_add_u32 s84, s86, 73728
    buffer_load_dwordx4 a[72:75], v3, s[40:43], s84 offen offset:0
    s_add_u32 s84, s86, 860160
    buffer_load_dwordx4 a[76:79], v3, s[40:43], s84 offen offset:0
    s_waitcnt vmcnt(10)
    s_add_u32 s84, s86, 73728
    buffer_load_dwordx4 a[80:83], v3, s[40:43], s84 offen offset:128
    s_add_u32 s84, s86, 860160
    buffer_load_dwordx4 a[84:87], v3, s[40:43], s84 offen offset:128
    s_waitcnt vmcnt(10)
    s_add_u32 s84, s86, 73728
    buffer_load_dwordx4 a[88:91], v3, s[40:43], s84 offen offset:256
    s_add_u32 s84, s86, 860160
    buffer_load_dwordx4 a[92:95], v3, s[40:43], s84 offen offset:256
    s_waitcnt vmcnt(10)
    s_add_u32 s84, s86, 98304
    buffer_load_dwordx4 a[96:99], v3, s[40:43], s84 offen offset:0
    s_add_u32 s84, s86, 884736
    buffer_load_dwordx4 a[100:103], v3, s[40:43], s84 offen offset:0
    s_waitcnt vmcnt(10)
    s_add_u32 s84, s86, 98304
    buffer_load_dwordx4 a[104:107], v3, s[40:43], s84 offen offset:128
    s_add_u32 s84, s86, 884736
    buffer_load_dwordx4 a[108:111], v3, s[40:43], s84 offen offset:128
    s_waitcnt vmcnt(10)
    s_add_u32 s84, s86, 98304
    buffer_load_dwordx4 a[112:115], v3, s[40:43], s84 offen offset:256
    s_add_u32 s84, s86, 884736
    buffer_load_dwordx4 a[116:119], v3, s[40:43], s84 offen offset:256
    s_waitcnt vmcnt(10)
    s_add_u32 s84, s86, 122880
    buffer_load_dwordx4 a[120:123], v3, s[40:43], s84 offen offset:0
    s_add_u32 s84, s86, 909312
    buffer_load_dwordx4 a[124:127], v3, s[40:43], s84 offen offset:0
    s_waitcnt vmcnt(10)
    s_add_u32 s84, s86, 122880
    buffer_load_dwordx4 a[128:131], v3, s[40:43], s84 offen offset:128
    s_add_u32 s84, s86, 909312
    buffer_load_dwordx4 a[132:135], v3, s[40:43], s84 offen offset:128
    s_waitcnt vmcnt(10)
    s_add_u32 s84, s86, 122880
    buffer_load_dwordx4 a[136:139], v3, s[40:43], s84 offen offset:256
    s_add_u32 s84, s86, 909312
    buffer_load_dwordx4 a[140:143], v3, s[40:43], s84 offen offset:256
    s_waitcnt vmcnt(10)
    s_add_u32 s84, s86, 147456
    buffer_load_dwordx4 a[144:147], v3, s[40:43], s84 offen offset:0
    s_add_u32 s84, s86, 933888
    buffer_load_dwordx4 a[148:151], v3, s[40:43], s84 offen offset:0
    s_waitcnt vmcnt(10)
    s_add_u32 s84, s86, 147456
    buffer_load_dwordx4 a[152:155], v3, s[40:43], s84 offen offset:128
    s_add_u32 s84, s86, 933888
    buffer_load_dwordx4 a[156:159], v3, s[40:43], s84 offen offset:128
    s_waitcnt vmcnt(10)
    s_add_u32 s84, s86, 147456
    buffer_load_dwordx4 a[160:163], v3, s[40:43], s84 offen offset:256
    s_add_u32 s84, s86, 933888
    buffer_load_dwordx4 a[164:167], v3, s[40:43], s84 offen offset:256
    s_waitcnt vmcnt(10)
    s_add_u32 s84, s86, 172032
    buffer_load_dwordx4 a[168:171], v3, s[40:43], s84 offen offset:0
    s_add_u32 s84, s86, 958464
    buffer_load_dwordx4 a[172:175], v3, s[40:43], s84 offen offset:0
    s_waitcnt vmcnt(10)
    s_add_u32 s84, s86, 172032
    buffer_load_dwordx4 a[176:179], v3, s[40:43], s84 offen offset:128
    s_add_u32 s84, s86, 958464
    buffer_load_dwordx4 a[180:183], v3, s[40:43], s84 offen offset:128
    s_waitcnt vmcnt(10)
    s_add_u32 s84, s86, 172032
    buffer_load_dwordx4 a[184:187], v3, s[40:43], s84 offen offset:256
    s_add_u32 s84, s86, 958464
    buffer_load_dwordx4 a[188:191], v3, s[40:43], s84 offen offset:256
    s_waitcnt vmcnt(10)
    s_add_u32 s84, s87, 0
    buffer_load_dwordx4 a[192:195], v3, s[40:43], s84 offen offset:0
    s_add_u32 s84, s87, 786432
    buffer_load_dwordx4 a[196:199], v3, s[40:43], s84 offen offset:0
    s_waitcnt vmcnt(10)
    s_add_u32 s84, s87, 0
    buffer_load_dwordx4 a[200:203], v3, s[40:43], s84 offen offset:128
    s_add_u32 s84, s87, 786432
    buffer_load_dwordx4 a[204:207], v3, s[40:43], s84 offen offset:128
    s_waitcnt vmcnt(10)
    s_add_u32 s84, s87, 0
    buffer_load_dwordx4 a[208:211], v3, s[40:43], s84 offen offset:256
    s_add_u32 s84, s87, 786432
    buffer_load_dwordx4 a[212:215], v3, s[40:43], s84 offen offset:256
    s_waitcnt vmcnt(10)
    s_add_u32 s84, s87, 24576
    buffer_load_dwordx4 a[216:219], v3, s[40:43], s84 offen offset:0
    s_add_u32 s84, s87, 811008
    buffer_load_dwordx4 a[220:223], v3, s[40:43], s84 offen offset:0
    s_waitcnt vmcnt(10)
    s_add_u32 s84, s87, 24576
    buffer_load_dwordx4 a[224:227], v3, s[40:43], s84 offen offset:128
    s_add_u32 s84, s87, 811008
    buffer_load_dwordx4 a[228:231], v3, s[40:43], s84 offen offset:128
    s_waitcnt vmcnt(10)
    s_add_u32 s84, s87, 24576
    buffer_load_dwordx4 a[232:235], v3, s[40:43], s84 offen offset:256
    s_add_u32 s84, s87, 811008
    buffer_load_dwordx4 a[236:239], v3, s[40:43], s84 offen offset:256
    s_setpc_b64 s[100:101]
L_burst_wo:
    s_waitcnt vmcnt(10)
    s_mov_b32 s84, 0
    buffer_load_dwordx4 a[240:243], v4, s[44:47], s84 offen offset:0
    s_mov_b32 s84, 5120
    buffer_load_dwordx4 a[244:247], v4, s[44:47], s84 offen offset:0
    s_waitcnt vmcnt(10)
    s_mov_b32 s84, 0
    buffer_load_dwordx4 a[248:251], v4, s[44:47], s84 offen offset:256
    s_mov_b32 s84, 5120
    buffer_load_dwordx4 a[252:255], v4, s[44:47], s84 offen offset:256
    s_waitcnt vmcnt(10)
    s_mov_b32 s84, 0
    buffer_load_dwordx4 a[0:3], v4, s[44:47], s84 offen offset:512
    s_mov_b32 s84, 5120
    buffer_load_dwordx4 a[4:7], v4, s[44:47], s84 offen offset:512
    s_waitcnt vmcnt(10)
    s_mov_b32 s84, 0
    buffer_load_dwordx4 a[8:11], v4, s[44:47], s84 offen offset:768
    s_mov_b32 s84, 5120
    buffer_load_dwordx4 a[12:15], v4, s[44:47], s84 offen offset:768
    s_waitcnt vmcnt(10)
    s_mov_b32 s84, 0
    buffer_load_dwordx4 a[16:19], v4, s[44:47], s84 offen offset:1024
    s_mov_b32 s84, 5120
    buffer_load_dwordx4 a[20:23], v4, s[44:47], s84 offen offset:1024
    s_waitcnt vmcnt(10)
    s_mov_b32 s84, 10240
    buffer_load_dwordx4 a[24:27], v4, s[44:47], s84 offen offset:0
    s_mov_b32 s84, 15360
    buffer_load_dwordx4 a[28:31], v4, s[44:47], s84 offen offset:0
    s_waitcnt vmcnt(10)
    s_mov_b32 s84, 10240
    buffer_load_dwordx4 a[32:35], v4, s[44:47], s84 offen offset:256
    s_mov_b32 s84, 15360
    buffer_load_dwordx4 a[36:39], v4, s[44:47], s84 offen offset:256
    s_waitcnt vmcnt(10)
    s_mov_b32 s84, 10240
    buffer_load_dwordx4 a[40:43], v4, s[44:47], s84 offen offset:512
    s_mov_b32 s84, 15360
    buffer_load_dwordx4 a[44:47], v4, s[44:47], s84 offen offset:512
    s_waitcnt vmcnt(10)
    s_mov_b32 s84, 10240
    buffer_load_dwordx4 a[48:51], v4, s[44:47], s84 offen offset:768
    s_mov_b32 s84, 15360
    buffer_load_dwordx4 a[52:55], v4, s[44:47], s84 offen offset:768
    s_waitcnt vmcnt(10)
    s_mov_b32 s84, 10240
    buffer_load_dwordx4 a[56:59], v4, s[44:47], s84 offen offset:1024
    s_mov_b32 s84, 15360
    buffer_load_dwordx4 a[60:63], v4, s[44:47], s84 offen offset:1024
    s_waitcnt vmcnt(10)
    s_mov_b32 s84, 81920
    buffer_load_dwordx4 a[64:67], v4, s[44:47], s84 offen offset:0
    s_mov_b32 s84, 87040
    buffer_load_dwordx4 a[68:71], v4, s[44:47], s84 offen offset:0
    s_waitcnt vmcnt(10)
    s_mov_b32 s84, 81920
    buffer_load_dwordx4 a[72:75], v4, s[44:47], s84 offen offset:256
    s_mov_b32 s84, 87040
    buffer_load_dwordx4 a[76:79], v4, s[44:47], s84 offen offset:256
    s_waitcnt vmcnt(10)
    s_mov_b32 s84, 81920
    buffer_load_dwordx4 a[80:83], v4, s[44:47], s84 offen offset:512
    s_mov_b32 s84, 87040
    buffer_load_dwordx4 a[84:87], v4, s[44:47], s84 offen offset:512
    s_waitcnt vmcnt(10)
    s_mov_b32 s84, 81920
    buffer_load_dwordx4 a[88:91], v4, s[44:47], s84 offen offset:768
    s_mov_b32 s84, 87040
    buffer_load_dwordx4 a[92:95], v4, s[44:47], s84 offen offset:768
    s_waitcnt vmcnt(10)
    s_mov_b32 s84, 81920
    buffer_load_dwordx4 a[96:99], v4, s[44:47], s84 offen offset:1024
    s_mov_b32 s84, 87040
    buffer_load_dwordx4 a[100:103], v4, s[44:47], s84 offen offset:1024
    s_waitcnt vmcnt(10)
    s_mov_b32 s84, 92160
    buffer_load_dwordx4 a[104:107], v4, s[44:47], s84 offen offset:0
    s_mov_b32 s84, 97280
    buffer_load_dwordx4 a[108:111], v4, s[44:47], s84 offen offset:0
    s_waitcnt vmcnt(10)
    s_mov_b32 s84, 92160
    buffer_load_dwordx4 a[112:115], v4, s[44:47], s84 offen offset:256
    s_mov_b32 s84, 97280
    buffer_load_dwordx4 a[116:119], v4, s[44:47], s84 offen offset:256
    s_waitcnt vmcnt(10)
    s_mov_b32 s84, 92160
    buffer_load_dwordx4 a[120:123], v4, s[44:47], s84 offen offset:512
    s_mov_b32 s84, 97280
    buffer_load_dwordx4 a[124:127], v4, s[44:47], s84 offen offset:512
    s_waitcnt vmcnt(10)
    s_mov_b32 s84, 92160
    buffer_load_dwordx4 a[128:131], v4, s[44:47], s84 offen offset:768
    s_mov_b32 s84, 97280
    buffer_load_dwordx4 a[132:135], v4, s[44:47], s84 offen offset:768
    s_waitcnt vmcnt(10)
    s_mov_b32 s84, 92160
    buffer_load_dwordx4 a[136:139], v4, s[44:47], s84 offen offset:1024
    s_mov_b32 s84, 97280
    buffer_load_dwordx4 a[140:143], v4, s[44:47], s84 offen offset:1024
    s_waitcnt vmcnt(10)
    s_mov_b32 s84, 163840
    buffer_load_dwordx4 a[144:147], v4, s[44:47], s84 offen offset:0
    s_mov_b32 s84, 168960
    buffer_load_dwordx4 a[148:151], v4, s[44:47], s84 offen offset:0
    s_waitcnt vmcnt(10)
    s_mov_b32 s84, 163840
    buffer_load_dwordx4 a[152:155], v4, s[44:47], s84 offen offset:256
    s_mov_b32 s84, 168960
    buffer_load_dwordx4 a[156:159], v4, s[44:47], s84 offen offset:256
    s_waitcnt vmcnt(10)
    s_mov_b32 s84, 163840
    buffer_load_dwordx4 a[160:163], v4, s[44:47], s84 offen offset:512
    s_mov_b32 s84, 168960
    buffer_load_dwordx4 a[164:167], v4, s[44:47], s84 offen offset:512
    s_waitcnt vmcnt(10)
    s_mov_b32 s84, 163840
    buffer_load_dwordx4 a[168:171], v4, s[44:47], s84 offen offset:768
    s_mov_b32 s84, 168960
    buffer_load_dwordx4 a[172:175], v4, s[44:47], s84 offen offset:768
    s_waitcnt vmcnt(10)
    s_mov_b32 s84, 163840
    buffer_load_dwordx4 a[176:179], v4, s[44:47], s84 offen offset:1024
    s_mov_b32 s84, 168960
    buffer_load_dwordx4 a[180:183], v4, s[44:47], s84 offen offset:1024
    s_waitcnt vmcnt(10)
    s_mov_b32 s84, 174080
    buffer_load_dwordx4 a[184:187], v4, s[44:47], s84 offen offset:0
    s_mov_b32 s84, 179200
    buffer_load_dwordx4 a[188:191], v4, s[44:47], s84 offen offset:0
    s_waitcnt vmcnt(10)
    s_mov_b32 s84, 174080
    buffer_load_dwordx4 a[192:195], v4, s[44:47], s84 offen offset:256
    s_mov_b32 s84, 179200
    buffer_load_dwordx4 a[196:199], v4, s[44:47], s84 offen offset:256
    s_waitcnt vmcnt(10)
    s_mov_b32 s84, 174080
    buffer_load_dwordx4 a[200:203], v4, s[44:47], s84 offen offset:512
    s_mov_b32 s84, 179200
    buffer_load_dwordx4 a[204:207], v4, s[44:47], s84 offen offset:512
    s_waitcnt vmcnt(10)
    s_mov_b32 s84, 174080
    buffer_load_dwordx4 a[208:211], v4, s[44:47], s84 offen offset:768
    s_mov_b32 s84, 179200
    buffer_load_dwordx4 a[212:215], v4, s[44:47], s84 offen offset:768
    s_waitcnt vmcnt(10)
    s_mov_b32 s84, 174080
    buffer_load_dwordx4 a[216:219], v4, s[44:47], s84 offen offset:1024
    s_mov_b32 s84, 179200
    buffer_load_dwordx4 a[220:223], v4, s[44:47], s84 offen offset:1024
    s_setpc_b64 s[100:101]
L_burst_w1:
    s_waitcnt vmcnt(10)
    s_add_u32 s84, s88, 0
    buffer_load_dwordx4 a[224:227], v6, s[48:51], s84 offen offset:0
    s_add_u32 s84, s88, 196608
    buffer_load_dwordx4 a[228:231], v6, s[48:51], s84 offen offset:0
    s_waitcnt vmcnt(10)
    s_add_u32 s84, s88, 49152
    buffer_load_dwordx4 a[232:235], v6, s[48:51], s84 offen offset:0
    s_add_u32 s84, s88, 245760
    buffer_load_dwordx4 a[236:239], v6, s[48:51], s84 offen offset:0
    s_waitcnt vmcnt(10)
    s_add_u32 s84, s88, 98304
    buffer_load_dwordx4 v[248:251], v6, s[48:51], s84 offen offset:0
    s_add_u32 s84, s88, 294912
    buffer_load_dwordx4 v[252:255], v6, s[48:51], s84 offen offset:0
    s_waitcnt vmcnt(10)
    s_add_u32 s84, s88, 147456
    buffer_load_dwordx4 v[240:243], v6, s[48:51], s84 offen offset:0
    s_add_u32 s84, s88, 344064
    buffer_load_dwordx4 v[244:247], v6, s[48:51], s84 offen offset:0
    s_waitcnt vmcnt(10)
    s_add_u32 s84, s88, 3072
    buffer_load_dwordx4 v[232:235], v6, s[48:51], s84 offen offset:0
    s_add_u32 s84, s88, 199680
    buffer_load_dwordx4 v[236:239], v6, s[48:51], s84 offen offset:0
    s_waitcnt vmcnt(10)
    s_add_u32 s84, s88, 52224
    buffer_load_dwordx4 v[224:227], v6, s[48:51], s84 offen offset:0
    s_add_u32 s84, s88, 248832
    buffer_load_dwordx4 v[228:231], v6, s[48:51], s84 offen offset:0
    s_waitcnt vmcnt(10)
    s_add_u32 s84, s88, 101376
    buffer_load_dwordx4 v[216:219], v6, s[48:51], s84 offen offset:0
    s_add_u32 s84, s88, 297984
    buffer_load_dwordx4 v[220:223], v6, s[48:51], s84 offen offset:0
    s_waitcnt vmcnt(10)
    s_add_u32 s84, s88, 150528
    buffer_load_dwordx4 v[208:211], v6, s[48:51], s84 offen offset:0
    s_add_u32 s84, s88, 347136
    buffer_load_dwordx4 v[212:215], v6, s[48:51], s84 offen offset:0
    s_waitcnt vmcnt(10)
    s_add_u32 s84, s89, 0
    buffer_load_dwordx4 v[200:203], v6, s[48:51], s84 offen offset:0
    s_add_u32 s84, s89, 196608
    buffer_load_dwordx4 v[204:207], v6, s[48:51], s84 offen offset:0
    s_waitcnt vmcnt(10)
    s_add_u32 s84, s89, 49152
    buffer_load_dwordx4 v[184:187], v6, s[48:51], s84 offen offset:0
    s_add_u32 s84, s89, 245760
    buffer_load_dwordx4 v[188:191], v6, s[48:51], s84 offen offset:0
    s_setpc_b64 s[100:101]
L_codeend:
.section .rodata,"a"
.p2align 6
.amdhsa_kernel sequential_preLN__sliding_block_cached__dense_activation_silu__decode_kernel
  .amdhsa_next_free_vgpr 512
  .amdhsa_next_free_sgpr 102
  .amdhsa_accum_offset 256
  .amdhsa_float_denorm_mode_32 3
  .amdhsa_group_segment_fixed_size 0
  .amdhsa_kernarg_size 88
  .amdhsa_user_sgpr_count 2
  .amdhsa_user_sgpr_kernarg_segment_ptr 1
  .amdhsa_system_sgpr_workgroup_id_x 1
.end_amdhsa_kernel
```
